```python
import torch

def _softmax(x, axis=-1):
    return torch.softmax(x, dim=axis)
def _gelu(x):
    return torch.nn.functional.gelu(x, approximate="tanh")
def _silu(x):
    return torch.nn.functional.silu(x)
def _sigmoid(x):
    return torch.sigmoid(x)
def _layernorm(x, axis=-1, eps=1e-5):
    m = x.mean(dim=axis, keepdim=True)
    v = x.var(dim=axis, keepdim=True, unbiased=False)
    return (x - m) / torch.sqrt(v + eps)
def _scatter_add(tgt, idx, src, axis=0):
    return tgt.clone().index_add_(axis, idx, src)
def _segment_sum(src, seg, n):
    out = torch.zeros((n,) + src.shape[1:], dtype=src.dtype)
    return out.index_add_(0, seg, src)
def _pad(x, pw):
    flat = tuple(v for pair in reversed(pw) for v in pair)
    return torch.nn.functional.pad(x, flat)

kernel_name = 'parallel_sum__linear_attn_block__dense_activation_mish__prompt'

def setup_inputs():

    _w = (lambda a: (lambda t: t.to(torch.bfloat16) if t.is_floating_point() else t)(torch.as_tensor(a)))
    def _A_setup():
        B, S, D = 1, 2048, 640
        return {
            "x": _w((lambda *s: torch.randn(*s, dtype=torch.bfloat16) * 0.05)(B, S, D)),
            "wqkv": _w((lambda *s: torch.randn(*s, dtype=torch.bfloat16) * 0.1)(D, 3 * D)),
            "wo": _w((lambda *s: torch.randn(*s, dtype=torch.bfloat16) * 0.05)(D, D)),
        }
    _A_in = _A_setup()

    def _B_setup():
        B, S, D, F = 1, 2048, 640, 1536
        return {
            "x": _w((lambda *s: torch.randn(*s, dtype=torch.bfloat16) * 0.05)(B, S, D)),
            "w1": _w((lambda *s: torch.randn(*s, dtype=torch.bfloat16) * 0.8)(D, F) * (D ** -0.5)),
            "b1": _w((lambda *s: torch.randn(*s, dtype=torch.bfloat16) * 0.4)(F)),
            "w2": _w((lambda *s: torch.randn(*s, dtype=torch.bfloat16) * 0.1)(F, D) * (F ** -0.5)),
        }
    _B_in = _B_setup()

    return {
        "A_x": _A_in["x"],
        "A_wqkv": _A_in["wqkv"],
        "A_wo": _A_in["wo"],
        "B_x": _B_in["x"],
        "B_w1": _B_in["w1"],
        "B_b1": _B_in["b1"],
        "B_w2": _B_in["w2"],
    }

def reference(A_x, A_wqkv, A_wo, B_x, B_w1, B_b1, B_w2):
    def _A_ref(x, wqkv, wo):
        B, S, D = x.shape
        H = 32; Dh = D // H
        qkv = (lambda x, *d: x.permute(*d))((x @ wqkv).reshape(B, S, 3, H, Dh), 2, 0, 3, 1, 4)
        q, k, v = qkv[0], qkv[1], qkv[2]
        phi = lambda t: torch.where(t > 0, t + 1, torch.exp(t)) + 1e-6
        pq, pk = phi(q), phi(k)
        kv = torch.einsum("bhsd,bhse->bhde", pk, v)
        z = torch.einsum("bhsd->bhd", pk)
        num = torch.einsum("bhqd,bhde->bhqe", pq, kv)
        den = torch.einsum("bhqd,bhd->bhq", pq, z)[..., None] + 1e-6
        o = num / den
        return (lambda x, *d: x.permute(*d))(o, 0, 2, 1, 3).reshape(B, S, D) @ wo

    def _B_ref(x, w1, b1, w2):
        h = torch.einsum("bsd,df->bsf", x, w1) + b1
        sp = torch.log1p(torch.exp(-torch.abs(h))) + torch.where(h > 0, h, torch.zeros_like(h))
        act = h * torch.tanh(sp)
        return torch.einsum("bsf,fd->bsd", act, w2)

    x = A_x
    xn = _layernorm(x, axis=-1)
    return x + _A_ref(xn, A_wqkv, A_wo) + _B_ref(xn, B_w1, B_b1, B_w2)
```

```asm
; @launch grid=(256,1,1) block=(256,1,1) lds=163840
.amdgcn_target "amdgcn-amd-amdhsa--gfx950"
.text
.globl parallel_sum__linear_attn_block__dense_activation_mish__prompt_kernel
.p2align 8
.type parallel_sum__linear_attn_block__dense_activation_mish__prompt_kernel,@function
parallel_sum__linear_attn_block__dense_activation_mish__prompt_kernel:
s_cmp_ge_u32 s2, 256
s_cbranch_scc1 L_end
s_load_dwordx2 s[4:5], s[0:1], 0
s_load_dwordx2 s[16:17], s[0:1], 32
s_load_dwordx2 s[32:33], s[0:1], 72
s_load_dwordx2 s[8:9], s[0:1], 8
s_getpc_b64 s[50:51]
L_pc:
s_bfe_u32 s45, s2, 131075
s_lshl_b32 s45, s45, 13
v_lshl_add_u32 v2, v0, 5, s45
v_min_u32 v2, L_end-L_pc, v2
v_mov_b32 v3, s51
v_add_co_u32 v2, vcc, s50, v2
s_nop 1
v_addc_co_u32 v3, vcc, 0, v3, vcc
global_load_dword v180, v[2:3], off
s_load_dwordx2 s[36:37], s[0:1], 64
s_load_dwordx2 s[12:13], s[0:1], 16
s_load_dwordx2 s[20:21], s[0:1], 40
s_load_dwordx2 s[24:25], s[0:1], 48
s_load_dwordx2 s[28:29], s[0:1], 56
v_lshrrev_b32 v1, 6, v0
v_and_b32 v0, 63, v0
v_readfirstlane_b32 s40, v1
s_and_b32 s45, s2, 7
s_lshr_b32 s46, s2, 3
s_and_b32 s47, s45, 1
s_lshr_b32 s49, s45, 1
s_lshl_b32 s50, s49, 2
s_and_b32 s48, s46, 3
s_add_u32 s41, s50, s48
s_lshl_b32 s50, s47, 3
s_lshr_b32 s51, s46, 2
s_add_u32 s42, s50, s51
v_lshlrev_b32 v232, 4, v0
v_lshrrev_b32 v200, 5, v0
v_and_b32 v201, 31, v0
v_mul_u32_u24 v207, 0x500, v200
s_lshl_b32 s45, s41, 4
s_add_u32 s45, s45, s42
v_lshl_add_u32 v209, v201, 3, v207
v_lshl_add_u32 v207, v201, 4, v207
s_lshl_b32 s46, s45, 2
s_add_u32 s46, s46, s40
s_lshl_b32 s59, s46, 1
s_mul_i32 s55, s59, 1280
v_lshrrev_b32 v200, 4, v0
v_and_b32 v201, 15, v0
v_min_u32 v202, 14, v201
v_mul_u32_u24 v203, 52, v202
v_lshrrev_b32 v203, 8, v203
v_mul_u32_u24 v204, 0xf00, v200
v_lshl_add_u32 v204, v202, 4, v204
s_movk_i32 s47, 1200
v_mad_u32_u24 v204, v203, s47, v204
v_min_u32 v202, 11, v201
v_mul_u32_u24 v205, 0xc00, v200
v_lshl_add_u32 v205, v202, 4, v205
s_mov_b32 s6, 2621440
s_mov_b32 s7, 0x20000
s_mov_b32 s18, 1966080
s_mov_b32 s19, 0x20000
s_mov_b32 s34, 19255296
s_mov_b32 s35, 0x20000
s_mov_b32 s10, 2457600
s_mov_b32 s11, 0x20000
v_mov_b32 v160, 0
v_mov_b32 v161, 0
v_mov_b32 v162, 0
v_mov_b32 v163, 0
s_waitcnt lgkmcnt(0)
s_or_b32 s0, s2, s40
s_mov_b32 s1, s59
s_cbranch_scc1 L_nz
s_movk_i32 s84, 4096
buffer_store_dwordx4 v[160:163], v232, s[32:35], 0 offen offset:0 sc1
buffer_store_dwordx4 v[160:163], v232, s[32:35], 0 offen offset:1024 sc1
buffer_store_dwordx4 v[160:163], v232, s[32:35], 0 offen offset:2048 sc1
buffer_store_dwordx4 v[160:163], v232, s[32:35], 0 offen offset:3072 sc1
buffer_store_dwordx4 v[160:163], v232, s[32:35], s84 offen sc1
L_nz:
buffer_load_dwordx4 v[180:183], v207, s[4:7], s55 offen
buffer_load_dwordx4 v[184:187], v207, s[4:7], s55 offen offset:512
buffer_load_dwordx2 v[188:189], v209, s[4:7], s55 offen offset:1024
s_mul_i32 s84, s41, 122880
s_mul_i32 s85, s42, 192
s_add_u32 s84, s84, s85
s_mul_i32 s85, s40, 12288
s_add_u32 s85, s85, s84
s_lshl_b32 s76, s40, 10
s_add_u32 m0, s76, 153600
s_nop 0
buffer_load_dwordx4 v205, s[16:19], s85 offen lds
s_add_u32 s85, s85, 49152
s_add_u32 m0, s76, 157696
s_nop 0
buffer_load_dwordx4 v205, s[16:19], s85 offen lds
s_min_u32 s76, s40, 1
s_mul_i32 s85, s76, 12288
s_add_u32 s85, s85, s84
s_add_u32 s85, s85, 98304
s_lshl_b32 s76, s76, 10
s_add_u32 m0, s76, 161792
s_nop 0
buffer_load_dwordx4 v205, s[16:19], s85 offen lds
s_mul_i32 s84, s41, 153600
s_mul_i32 s85, s42, 80
s_add_u32 s84, s84, s85
s_mul_i32 s85, s40, 15360
s_add_u32 s85, s85, s84
s_lshl_b32 s76, s40, 10
s_add_u32 m0, s76, 143360
s_nop 0
buffer_load_dwordx4 v204, s[8:11], s85 offen lds
s_add_u32 s85, s85, 61440
s_add_u32 m0, s76, 147456
s_nop 0
buffer_load_dwordx4 v204, s[8:11], s85 offen lds
s_min_u32 s76, s40, 1
s_mul_i32 s85, s76, 15360
s_add_u32 s85, s85, s84
s_add_u32 s85, s85, 122880
s_lshl_b32 s76, s76, 10
s_add_u32 m0, s76, 151552
s_nop 0
buffer_load_dwordx4 v204, s[8:11], s85 offen lds
v_lshrrev_b32 v200, 3, v0
v_mul_u32_u24 v200, 0x500, v200
v_and_b32 v201, 7, v0
v_lshrrev_b32 v202, 4, v0
v_xor_b32 v201, v201, v202
v_lshl_add_u32 v96, v201, 4, v200
v_xor_b32 v201, 4, v201
v_lshl_add_u32 v97, v201, 4, v200
v_add_u32 v98, 18432, v96
v_add_u32 v99, 27648, v97
v_add_u32 v97, 9216, v97
s_lshl_b32 s46, s41, 2
s_add_u32 s46, s46, s40
s_lshl_b32 s71, s46, 5
s_mul_i32 s60, s71, 1280
s_lshl_b32 s61, s40, 12
v_mov_b32 v200, v0
v_mul_u32_u24 v201, 0xaab, v200
v_lshrrev_b32 v201, 15, v201
v_mul_u32_u24 v201, 2880, v201
v_lshl_add_u32 v237, v200, 4, v201
v_add_u32 v200, 64, v0
v_mul_u32_u24 v201, 0xaab, v200
v_lshrrev_b32 v201, 15, v201
v_mul_u32_u24 v201, 2880, v201
v_lshl_add_u32 v238, v200, 4, v201
v_subrev_u32 v238, 1024, v238
v_add_u32 v200, 128, v0
v_mul_u32_u24 v201, 0xaab, v200
v_lshrrev_b32 v201, 15, v201
v_mul_u32_u24 v201, 2880, v201
v_lshl_add_u32 v239, v200, 4, v201
v_subrev_u32 v239, 2048, v239
s_mul_i32 s46, s40, 49152
s_mul_i32 s48, s42, 192
s_add_u32 s62, s46, s48
s_mul_i32 s63, s40, 3072
s_add_u32 s63, s63, 16384
s_mov_b32 s38, 256
s_mov_b32 s39, 0x20000
s_mov_b32 s14, 819200
s_mov_b32 s15, 0x20000
s_mov_b32 s22, 3072
s_mov_b32 s23, 0x20000
s_mov_b32 s26, 1966080
s_mov_b32 s27, 0x20000
s_mov_b32 s30, 2621440
s_mov_b32 s31, 0x20000
v_and_b32 v200, 31, v0
v_lshrrev_b32 v201, 5, v0
v_bfe_u32 v202, v0, 1, 3
v_xor_b32 v202, v202, v201
v_lshlrev_b32 v202, 4, v202
v_lshl_add_u32 v202, v200, 7, v202
v_add_u32 v202, s61, v202
v_xor_b32 v1, 0, v202
v_add_u32 v5, 57344, v1
v_add_u32 v9, 114688, v1
v_xor_b32 v2, 32, v202
v_add_u32 v6, 57344, v2
v_add_u32 v10, 114688, v2
v_xor_b32 v3, 64, v202
v_add_u32 v7, 57344, v3
v_add_u32 v11, 114688, v3
v_xor_b32 v4, 96, v202
v_add_u32 v8, 57344, v4
v_add_u32 v12, 114688, v4
v_bfe_u32 v202, v0, 2, 2
v_lshl_add_u32 v202, v201, 3, v202
v_mul_u32_u24 v202, 192, v202
v_bfe_u32 v203, v0, 4, 1
v_lshl_add_u32 v202, v203, 5, v202
v_and_b32 v203, 3, v0
v_lshl_add_u32 v13, v203, 3, v202
v_add_u32 v14, 57344, v13
v_add_u32 v15, 114688, v13
v_add_u32 v233, 57344, v232
v_add_u32 v234, 114688, v232
s_lshl_b32 s45, s41, 5
s_add_u32 s45, s45, s42
s_lshl_b32 s45, s45, 2
s_lshl_b32 s46, s42, 5
s_add_u32 s46, s46, s41
s_lshl_b32 s46, s46, 2
s_add_u32 s46, s46, 2048
s_cmp_eq_u32 s40, 0
s_cselect_b32 s45, s45, 0x40000000
s_cselect_b32 s46, s46, 0x40000000
v_mov_b32 v254, 0x40000000
v_writelane_b32 v254, s45, 0
v_writelane_b32 v254, s46, 1
v_mov_b32 v255, 1
v_bfe_u32 v200, v0, 4, 1
v_bfe_u32 v201, v0, 1, 1
v_lshl_add_u32 v200, v200, 1, v201
v_bfe_u32 v201, v0, 2, 2
v_and_b32 v202, 1, v0
v_lshlrev_b32 v202, 3, v202
v_lshl_add_u32 v201, v201, 8, v202
v_lshrrev_b32 v203, 5, v0
s_mov_b32 s46, 0xdcba8765
s_mov_b32 s47, 0x3210f4e9
s_lshl_b32 s48, s40, 4
s_lshr_b64 s[46:47], s[46:47], s48
v_lshlrev_b32 v220, 2, v200
v_lshrrev_b32 v220, v220, s46
v_and_b32 v220, 15, v220
v_lshl_add_u32 v208, v220, 4, v201
v_add_u32 v208, 143360, v208
v_lshl_add_u32 v206, v203, 11, v208
s_min_u32 s47, s40, 2
s_lshl_b32 s47, s47, 2
v_add_u32 v220, s47, v200
v_lshl_add_u32 v211, v220, 4, v201
v_add_u32 v211, 153600, v211
v_lshl_add_u32 v210, v203, 11, v211
v_mov_b32 v220, 0x3f803f80
v_cmp_gt_u32 vcc, 32, v0
v_mov_b32 v221, 0
v_mov_b32 v112, v220
v_cndmask_b32 v116, v221, v220, vcc
v_mov_b32 v113, v220
v_cndmask_b32 v117, v221, v220, vcc
v_mov_b32 v114, v220
v_cndmask_b32 v118, v221, v220, vcc
v_mov_b32 v115, v220
v_cndmask_b32 v119, v221, v220, vcc
s_mul_i32 s45, s41, 5
s_movk_i32 s46, 4096
v_and_b32 v202, 31, v0
v_lshlrev_b32 v202, 4, v202
v_add_u32 v200, s45, v203
v_add_u32 v200, 0, v200
v_and_b32 v201, 1, v200
v_lshrrev_b32 v200, 1, v200
v_lshl_add_u32 v201, v201, 9, v202
v_mad_u32_u24 v212, v200, s46, v201
v_add_u32 v200, s45, v203
v_add_u32 v200, 2, v200
v_and_b32 v201, 1, v200
v_lshrrev_b32 v200, 1, v200
v_lshl_add_u32 v201, v201, 9, v202
v_mad_u32_u24 v213, v200, s46, v201
v_add_u32 v200, s45, v203
v_add_u32 v200, 4, v200
v_and_b32 v201, 1, v200
v_lshrrev_b32 v200, 1, v200
v_lshl_add_u32 v201, v201, 9, v202
v_mad_u32_u24 v214, v200, s46, v201
s_mul_i32 s46, s42, 163840
s_add_u32 s87, s46, 65536
s_mul_i32 s65, s40, 6144
s_add_u32 s64, s87, s65
s_add_u32 s46, s87, 147456
s_add_u32 s66, s46, s61
s_and_b32 s48, s2, 7
s_lshr_b32 s49, s2, 3
s_lshr_b32 s50, s48, 1
s_lshl_b32 s50, s50, 3
s_and_b32 s51, s49, 7
s_add_u32 s43, s50, s51
s_and_b32 s50, s48, 1
s_lshl_b32 s50, s50, 2
s_lshr_b32 s51, s49, 3
s_add_u32 s44, s50, s51
s_lshl_b32 s48, s40, 6
v_add_u32 v104, s48, v0
v_add_u32 v105, 0, v104
v_min_u32 v105, 479, v105
v_mul_u32_u24 v106, 6554, v105
v_lshrrev_b32 v106, 16, v106
v_mul_u32_u24 v107, 160, v106
v_lshlrev_b32 v105, 4, v105
v_sub_u32 v105, v105, v107
v_mul_u32_u24 v106, 0x500, v106
v_add_u32 v100, v106, v105
v_add_u32 v105, 256, v104
v_min_u32 v105, 479, v105
v_mul_u32_u24 v106, 6554, v105
v_lshrrev_b32 v106, 16, v106
v_mul_u32_u24 v107, 160, v106
v_lshlrev_b32 v105, 4, v105
v_sub_u32 v105, v105, v107
v_mul_u32_u24 v106, 0x500, v106
v_add_u32 v101, v106, v105
v_add_u32 v105, 0, v104
v_min_u32 v105, 439, v105
v_mul_u32_u24 v106, 6554, v105
v_lshrrev_b32 v106, 16, v106
v_mul_u32_u24 v107, 160, v106
v_lshlrev_b32 v105, 4, v105
v_sub_u32 v105, v105, v107
v_add_u32 v107, 4, v106
v_cmp_le_u32 vcc, 16, v106
s_nop 0
s_nop 0
v_cndmask_b32 v106, v106, v107, vcc
v_mul_u32_u24 v106, 0x500, v106
v_add_u32 v102, v106, v105
v_add_u32 v105, 256, v104
v_min_u32 v105, 439, v105
v_mul_u32_u24 v106, 6554, v105
v_lshrrev_b32 v106, 16, v106
v_mul_u32_u24 v107, 160, v106
v_lshlrev_b32 v105, 4, v105
v_sub_u32 v105, v105, v107
v_add_u32 v107, 4, v106
v_cmp_le_u32 vcc, 32, v106
v_subrev_u32 v103, 16, v106
s_nop 0
v_cndmask_b32 v107, v107, v103, vcc
v_cmp_le_u32 vcc, 40, v106
v_subrev_u32 v103, 4, v106
s_nop 0
v_cndmask_b32 v106, v107, v103, vcc
v_mul_u32_u24 v106, 0x500, v106
v_add_u32 v103, v106, v105
s_lshl_b32 s48, s41, 2
s_add_u32 s48, s48, s40
s_lshl_b32 s48, s48, 1
s_mul_i32 s48, s48, 69632
s_add_u32 s48, s48, 5480448
s_mul_i32 s49, s42, 3072
s_add_u32 s68, s48, s49
s_mul_i32 s49, s42, 1280
s_add_u32 s48, s48, 49152
s_add_u32 s67, s48, s49
v_lshrrev_b32 v105, 5, v0
v_bfe_u32 v106, v0, 4, 1
v_mul_u32_u24 v106, 69632, v106
v_lshl_add_u32 v106, v105, 8, v106
v_and_b32 v107, 15, v0
v_lshl_add_u32 v240, v107, 4, v106
s_lshl_b32 s48, s41, 7
s_lshl_b32 s49, s42, 7
s_add_u32 s49, s49, 2048
v_and_b32 v216, 15, v0
v_lshlrev_b32 v216, 2, v216
v_add_u32 v217, s49, v216
v_add_u32 v216, s48, v216
s_mov_b32 s48, 0xffff0000
s_mov_b32 s49, 0xffff0000
v_cndmask_b32 v216, v216, v217, s[48:49]
v_lshrrev_b32 v104, 4, v0
s_lshl_b32 s48, s40, 2
v_add_u32 v104, s48, v104
v_bfe_u32 v108, v0, 2, 2
v_mul_u32_u24 v108, 160, v108
v_and_b32 v109, 3, v0
v_lshl_add_u32 v108, v109, 3, v108
v_add_u32 v108, 143360, v108
v_and_b32 v109, 15, v0
v_lshlrev_b32 v109, 4, v109
s_mul_i32 s49, s43, 6
s_lshr_b32 s50, s43, 1
s_mul_i32 s50, s50, 5
s_add_u32 s50, s50, 192
s_movk_i32 s51, 5120
s_and_b32 s52, s43, 1
s_mul_i32 s53, s52, 13
s_sub_u32 s52, 13, s52
s_movk_i32 s54, 2560
v_add_u32 v105, 0, v104
v_cmp_gt_u32 vcc, 30, v105
v_min_u32 v105, 29, v105
v_mul_u32_u24 v106, 52, v105
v_lshrrev_b32 v106, 8, v106
v_mul_u32_u24 v107, 5, v106
v_sub_u32 v105, v105, v107
v_lshrrev_b32 v107, 1, v106
v_mad_u32_u24 v124, v107, s54, v108
v_and_b32 v107, 1, v106
v_mul_u32_u24 v107, 640, v107
v_add_u32 v124, v107, v124
v_lshl_add_u32 v124, v105, 5, v124
v_add_u32 v106, s49, v106
v_lshrrev_b32 v107, 2, v106
v_and_b32 v106, 3, v106
v_lshl_add_u32 v106, v106, 8, v109
v_lshl_add_u32 v106, v105, 10, v106
v_mad_u32_u24 v106, v107, s51, v106
v_mov_b32 v107, 0x40000000
v_cndmask_b32 v127, v107, v106, vcc
v_add_u32 v105, 16, v104
v_cmp_gt_u32 vcc, 30, v105
v_min_u32 v105, 29, v105
v_mul_u32_u24 v106, 52, v105
v_lshrrev_b32 v106, 8, v106
v_mul_u32_u24 v107, 5, v106
v_sub_u32 v105, v105, v107
v_lshrrev_b32 v107, 1, v106
v_mad_u32_u24 v125, v107, s54, v108
v_and_b32 v107, 1, v106
v_mul_u32_u24 v107, 640, v107
v_add_u32 v125, v107, v125
v_lshl_add_u32 v125, v105, 5, v125
v_add_u32 v106, s49, v106
v_lshrrev_b32 v107, 2, v106
v_and_b32 v106, 3, v106
v_lshl_add_u32 v106, v106, 8, v109
v_lshl_add_u32 v106, v105, 10, v106
v_mad_u32_u24 v106, v107, s51, v106
v_mov_b32 v107, 0x40000000
v_cndmask_b32 v235, v107, v106, vcc
v_add_u32 v105, s53, v104
v_cmp_gt_u32 vcc, s52, v104
v_min_u32 v105, 24, v105
v_add_u32 v108, 8192, v108
v_mul_u32_u24 v106, 52, v105
v_lshrrev_b32 v106, 8, v106
v_mul_u32_u24 v107, 5, v106
v_sub_u32 v105, v105, v107
v_lshrrev_b32 v107, 1, v106
v_mad_u32_u24 v126, v107, s54, v108
v_and_b32 v107, 1, v106
v_mul_u32_u24 v107, 640, v107
v_add_u32 v126, v107, v126
v_lshl_add_u32 v126, v105, 5, v126
v_add_u32 v106, s50, v106
v_lshrrev_b32 v107, 2, v106
v_and_b32 v106, 3, v106
v_lshl_add_u32 v106, v106, 8, v109
v_lshl_add_u32 v106, v105, 10, v106
v_mad_u32_u24 v106, v107, s51, v106
v_mov_b32 v107, 0x40000000
v_cndmask_b32 v236, v107, v106, vcc
v_and_b32 v104, 31, v0
v_lshrrev_b32 v105, 5, v0
s_mov_b32 s69, 0x3f800008
s_mov_b32 s70, 0x358637bd
s_mov_b32 s74, 0xff00ff00
s_mov_b32 s75, 0xff00ff00
v_mov_b32 v153, s69
v_mov_b32 v154, s70
v_cndmask_b32 v153, v153, 0, s[74:75]
v_mov_b32 v152, 0xff7fffff
v_cndmask_b32 v154, v154, v152, s[74:75]
v_mov_b32 v152, 0x3fb8aa3b
s_add_u32 s48, s65, 86016
v_add_u32 v245, s48, v232
s_lshr_b32 s49, s40, 1
s_lshl_b32 s49, s49, 12
s_add_u32 s49, s49, 86016
v_add_u32 v246, s49, v232
s_and_b32 s49, s40, 1
s_lshl_b32 s49, s49, 11
s_add_u32 s49, s49, 88064
v_add_u32 v247, s49, v232
v_bfe_u32 v106, v0, 2, 2
v_and_b32 v107, 1, v0
v_lshl_add_u32 v106, v107, 5, v106
v_lshlrev_b32 v106, 4, v106
v_bfe_u32 v107, v0, 1, 1
v_lshl_add_u32 v106, v107, 3, v106
v_bfe_u32 v107, v0, 4, 1
v_lshl_add_u32 v106, v107, 10, v106
s_add_u32 s48, s48, 4352
v_add_u32 v248, s48, v106
s_lshl_b32 s48, s40, 10
s_add_u32 s48, s48, 159744
v_add_u32 v135, s48, v232
s_and_b32 s56, s40, 1
s_mul_i32 s57, s56, 24
v_add_u32 v109, s57, v104
s_cmp_eq_u32 s56, 1
s_cselect_b32 s48, 0x0100ff00, -1
s_cselect_b32 s50, 0x01000000, 0
s_mov_b32 s49, s48
s_mov_b32 s51, s50
s_lshr_b32 s56, s40, 1
v_cmp_le_u32 s[52:53], 20, v109
v_mov_b32 v111, 0x40000000
v_mov_b32 v110, 20
v_lshlrev_b32 v106, 2, v105
s_lshl_b32 s57, s56, 5
s_add_u32 s57, s57, 0
v_add_u32 v106, s57, v106
v_cmp_le_u32 vcc, 20, v106
s_nop 1
v_cndmask_b32 v107, 0, v110, vcc
v_sub_u32 v106, v106, v107
v_sub_u32 v108, v109, v107
v_cndmask_b32 v108, v108, v110, s[50:51]
v_lshrrev_b32 v107, 2, v107
v_mul_u32_u24 v107, 336, v107
v_mul_u32_u24 v108, 80, v108
v_lshl_add_u32 v106, v106, 2, v107
v_add_u32 v106, v106, v108
s_xnor_b64 s[54:55], vcc, s[52:53]
s_or_b64 s[54:55], s[54:55], s[50:51]
s_and_b64 s[54:55], s[54:55], s[48:49]
v_cndmask_b32 v241, v111, v106, s[54:55]
v_lshlrev_b32 v106, 2, v105
s_lshl_b32 s57, s56, 5
s_add_u32 s57, s57, 8
v_add_u32 v106, s57, v106
v_cmp_le_u32 vcc, 20, v106
s_nop 1
v_cndmask_b32 v107, 0, v110, vcc
v_sub_u32 v106, v106, v107
v_sub_u32 v108, v109, v107
v_cndmask_b32 v108, v108, v110, s[50:51]
v_lshrrev_b32 v107, 2, v107
v_mul_u32_u24 v107, 336, v107
v_mul_u32_u24 v108, 80, v108
v_lshl_add_u32 v106, v106, 2, v107
v_add_u32 v106, v106, v108
s_xnor_b64 s[54:55], vcc, s[52:53]
s_or_b64 s[54:55], s[54:55], s[50:51]
s_and_b64 s[54:55], s[54:55], s[48:49]
s_cmp_eq_u32 s56, 0
s_cselect_b64 s[54:55], s[54:55], 0
v_cndmask_b32 v242, v111, v106, s[54:55]
v_lshlrev_b32 v106, 2, v105
s_lshl_b32 s57, s56, 5
s_add_u32 s57, s57, 16
v_add_u32 v106, s57, v106
v_cmp_le_u32 vcc, 20, v106
s_nop 1
v_cndmask_b32 v107, 0, v110, vcc
v_sub_u32 v106, v106, v107
v_sub_u32 v108, v109, v107
v_cndmask_b32 v108, v108, v110, s[50:51]
v_lshrrev_b32 v107, 2, v107
v_mul_u32_u24 v107, 336, v107
v_mul_u32_u24 v108, 80, v108
v_lshl_add_u32 v106, v106, 2, v107
v_add_u32 v106, v106, v108
s_xnor_b64 s[54:55], vcc, s[52:53]
s_or_b64 s[54:55], s[54:55], s[50:51]
s_and_b64 s[54:55], s[54:55], s[48:49]
s_cmp_eq_u32 s56, 0
s_cselect_b64 s[54:55], s[54:55], 0
v_cndmask_b32 v243, v111, v106, s[54:55]
v_lshlrev_b32 v106, 2, v105
s_lshl_b32 s57, s56, 5
s_add_u32 s57, s57, 24
v_add_u32 v106, s57, v106
v_cmp_le_u32 vcc, 20, v106
s_nop 1
v_cndmask_b32 v107, 0, v110, vcc
v_sub_u32 v106, v106, v107
v_sub_u32 v108, v109, v107
v_cndmask_b32 v108, v108, v110, s[50:51]
v_lshrrev_b32 v107, 2, v107
v_mul_u32_u24 v107, 336, v107
v_mul_u32_u24 v108, 80, v108
v_lshl_add_u32 v106, v106, 2, v107
v_add_u32 v106, v106, v108
s_xnor_b64 s[54:55], vcc, s[52:53]
s_or_b64 s[54:55], s[54:55], s[50:51]
s_and_b64 s[54:55], s[54:55], s[48:49]
s_cmp_eq_u32 s56, 0
s_cselect_b64 s[54:55], s[54:55], 0
v_cndmask_b32 v244, v111, v106, s[54:55]
s_add_u32 m0, s61, 0
s_add_u32 s76, s60, 0
buffer_load_dwordx4 v96, s[4:7], s76 offen offset:0 lds
buffer_load_dwordx4 v97, s[4:7], s76 offen offset:1024 lds
buffer_load_dwordx4 v98, s[4:7], s76 offen offset:2048 lds
buffer_load_dwordx4 v99, s[4:7], s76 offen offset:3072 lds
s_add_u32 m0, s63, 0
s_add_u32 s77, s62, 0
buffer_load_dwordx4 v237, s[16:19], s77 offen offset:0 lds
buffer_load_dwordx4 v238, s[16:19], s77 offen offset:1024 lds
buffer_load_dwordx4 v239, s[16:19], s77 offen offset:2048 lds
s_waitcnt vmcnt(15)
v_lshlrev_b32 v160, 16, v180
v_and_b32 v161, 0xffff0000, v180
s_cmp_eq_u32 s0, 0
s_cbranch_scc0 L_nz2
v_mov_b32 v200, 0
v_mov_b32 v201, 1
buffer_store_dword v201, v200, s[36:39], 0 offen sc1
L_nz2:
v_lshlrev_b32 v162, 16, v181
v_and_b32 v163, 0xffff0000, v181
v_lshlrev_b32 v164, 16, v182
v_and_b32 v165, 0xffff0000, v182
v_lshlrev_b32 v166, 16, v183
v_and_b32 v167, 0xffff0000, v183
s_waitcnt vmcnt(14)
v_lshlrev_b32 v168, 16, v184
v_and_b32 v169, 0xffff0000, v184
v_lshlrev_b32 v170, 16, v185
v_and_b32 v171, 0xffff0000, v185
v_lshlrev_b32 v172, 16, v186
v_and_b32 v173, 0xffff0000, v186
v_lshlrev_b32 v174, 16, v187
v_and_b32 v175, 0xffff0000, v187
s_waitcnt vmcnt(13)
v_lshlrev_b32 v176, 16, v188
v_and_b32 v177, 0xffff0000, v188
v_lshlrev_b32 v178, 16, v189
v_and_b32 v179, 0xffff0000, v189
v_add_f32 v200, v160, v161
v_add_f32 v201, v162, v163
v_add_f32 v200, v200, v164
v_add_f32 v201, v201, v165
v_add_f32 v200, v200, v166
v_add_f32 v201, v201, v167
v_add_f32 v200, v200, v168
v_add_f32 v201, v201, v169
v_add_f32 v200, v200, v170
v_add_f32 v201, v201, v171
v_add_f32 v200, v200, v172
v_add_f32 v201, v201, v173
v_add_f32 v200, v200, v174
v_add_f32 v201, v201, v175
v_add_f32 v200, v200, v176
v_add_f32 v201, v201, v177
v_add_f32 v200, v200, v178
v_add_f32 v201, v201, v179
v_add_f32 v200, v200, v201
s_nop 1
v_add_f32_dpp v200, v200, v200 row_ror:8 row_mask:0xf bank_mask:0xf
s_nop 1
v_add_f32_dpp v200, v200, v200 row_ror:4 row_mask:0xf bank_mask:0xf
s_nop 1
v_add_f32_dpp v200, v200, v200 row_ror:2 row_mask:0xf bank_mask:0xf
s_nop 1
v_add_f32_dpp v200, v200, v200 row_ror:1 row_mask:0xf bank_mask:0xf
v_mov_b32 v201, v200
s_nop 1
v_permlane16_swap_b32 v200, v201
v_add_f32 v200, v200, v201
v_mul_f32 v200, 0xbacccccd, v200
v_add_f32 v160, v160, v200
v_add_f32 v161, v161, v200
v_add_f32 v162, v162, v200
v_add_f32 v163, v163, v200
v_add_f32 v164, v164, v200
v_add_f32 v165, v165, v200
v_add_f32 v166, v166, v200
v_add_f32 v167, v167, v200
v_add_f32 v168, v168, v200
v_add_f32 v169, v169, v200
v_add_f32 v170, v170, v200
v_add_f32 v171, v171, v200
v_add_f32 v172, v172, v200
v_add_f32 v173, v173, v200
v_add_f32 v174, v174, v200
v_add_f32 v175, v175, v200
v_add_f32 v176, v176, v200
v_add_f32 v177, v177, v200
v_add_f32 v178, v178, v200
v_add_f32 v179, v179, v200
v_mul_f32 v201, v160, v160
v_mul_f32 v202, v161, v161
v_fmac_f32 v201, v162, v162
v_fmac_f32 v202, v163, v163
v_fmac_f32 v201, v164, v164
v_fmac_f32 v202, v165, v165
v_fmac_f32 v201, v166, v166
v_fmac_f32 v202, v167, v167
v_fmac_f32 v201, v168, v168
v_fmac_f32 v202, v169, v169
v_fmac_f32 v201, v170, v170
v_fmac_f32 v202, v171, v171
v_fmac_f32 v201, v172, v172
v_fmac_f32 v202, v173, v173
v_fmac_f32 v201, v174, v174
v_fmac_f32 v202, v175, v175
v_fmac_f32 v201, v176, v176
v_fmac_f32 v202, v177, v177
v_fmac_f32 v201, v178, v178
v_fmac_f32 v202, v179, v179
v_add_f32 v201, v201, v202
s_nop 1
v_add_f32_dpp v201, v201, v201 row_ror:8 row_mask:0xf bank_mask:0xf
s_nop 1
v_add_f32_dpp v201, v201, v201 row_ror:4 row_mask:0xf bank_mask:0xf
s_nop 1
v_add_f32_dpp v201, v201, v201 row_ror:2 row_mask:0xf bank_mask:0xf
s_nop 1
v_add_f32_dpp v201, v201, v201 row_ror:1 row_mask:0xf bank_mask:0xf
v_mov_b32 v202, v201
s_nop 1
v_permlane16_swap_b32 v201, v202
v_add_f32 v201, v201, v202
v_mov_b32 v202, 0x3727c5ac
v_fmac_f32 v202, 0x3acccccd, v201
v_rsq_f32 v220, v202
v_lshrrev_b32 v203, 5, v0
v_add_u32 v203, s1, v203
v_lshlrev_b32 v194, 4, v203
v_lshlrev_b32 v195, 2, v203
v_mul_f32 v201, v202, v220
v_cvt_pk_bf16_f32 v191, v200, v201
v_mov_b32 v193, v220
v_lshlrev_b32 v202, 16, v191
v_and_b32 v203, 0xffff0000, v191
v_sub_f32 v202, v200, v202
v_sub_f32 v203, v201, v203
v_cvt_pk_bf16_f32 v190, v200, v202
v_mov_b32 v221, 0
v_cvt_pk_bf16_f32 v192, v203, v221
s_mov_b32 s48, 14397440
s_mov_b32 s49, 14430208
s_mov_b32 exec_lo, 1
s_mov_b32 exec_hi, 1
buffer_store_dwordx4 v[190:193], v194, s[32:35], s48 offen sc1
buffer_store_dword v193, v195, s[32:35], s49 offen sc1
s_mov_b64 exec, -1
s_lshl_b32 s46, s42, 4
s_add_u32 s46, s46, s41
s_mul_i32 s46, s46, 3584
s_add_u32 s72, s46, 14667776
s_lshl_b32 s46, s40, 10
v_add_u32 v215, s46, v232
v_mov_b32 v200, 0x40000000
v_cmp_gt_u32 vcc, 3584, v215
v_mov_b32 v156, -1
v_mov_b32 v157, -1
v_mov_b32 v158, -1
v_mov_b32 v159, -1
v_cndmask_b32 v215, v200, v215, vcc
buffer_store_dwordx4 v[156:159], v215, s[32:35], s72 offen sc1
buffer_store_dwordx4 v[156:159], v240, s[32:35], s67 offen sc1
buffer_store_dwordx4 v[156:159], v240, s[32:35], s67 offen offset:512 sc1
s_mov_b32 exec_hi, 0
buffer_store_dwordx4 v[156:159], v240, s[32:35], s67 offen offset:1024 sc1
s_mov_b32 exec_hi, -1
s_add_u32 m0, s61, 28672
s_add_u32 s76, s60, 128
buffer_load_dwordx4 v96, s[4:7], s76 offen offset:0 lds
buffer_load_dwordx4 v97, s[4:7], s76 offen offset:1024 lds
buffer_load_dwordx4 v98, s[4:7], s76 offen offset:2048 lds
buffer_load_dwordx4 v99, s[4:7], s76 offen offset:3072 lds
s_add_u32 m0, s63, 28672
s_add_u32 s77, s62, 196608
buffer_load_dwordx4 v237, s[16:19], s77 offen offset:0 lds
buffer_load_dwordx4 v238, s[16:19], s77 offen offset:1024 lds
buffer_load_dwordx4 v239, s[16:19], s77 offen offset:2048 lds
s_add_u32 m0, s61, 57344
s_add_u32 s76, s60, 256
buffer_load_dwordx4 v96, s[4:7], s76 offen offset:0 lds
buffer_load_dwordx4 v97, s[4:7], s76 offen offset:1024 lds
buffer_load_dwordx4 v98, s[4:7], s76 offen offset:2048 lds
buffer_load_dwordx4 v99, s[4:7], s76 offen offset:3072 lds
s_add_u32 m0, s63, 57344
s_add_u32 s77, s62, 393216
buffer_load_dwordx4 v237, s[16:19], s77 offen offset:0 lds
buffer_load_dwordx4 v238, s[16:19], s77 offen offset:1024 lds
buffer_load_dwordx4 v239, s[16:19], s77 offen offset:2048 lds
s_add_u32 m0, s61, 86016
s_add_u32 s76, s60, 384
buffer_load_dwordx4 v96, s[4:7], s76 offen offset:0 lds
buffer_load_dwordx4 v97, s[4:7], s76 offen offset:1024 lds
buffer_load_dwordx4 v98, s[4:7], s76 offen offset:2048 lds
buffer_load_dwordx4 v99, s[4:7], s76 offen offset:3072 lds
s_add_u32 m0, s63, 86016
s_add_u32 s77, s62, 589824
buffer_load_dwordx4 v237, s[16:19], s77 offen offset:0 lds
buffer_load_dwordx4 v238, s[16:19], s77 offen offset:1024 lds
buffer_load_dwordx4 v239, s[16:19], s77 offen offset:2048 lds
s_waitcnt vmcnt(27)
s_barrier
ds_read_b128 a[0:3], v1 offset:0
ds_read_b64_tr_b16 a[160:161], v13 offset:16384
ds_read_b64_tr_b16 a[162:163], v13 offset:17152
ds_read_b64_tr_b16 a[164:165], v13 offset:16448
ds_read_b64_tr_b16 a[166:167], v13 offset:17216
ds_read_b64_tr_b16 a[168:169], v13 offset:16512
ds_read_b64_tr_b16 a[170:171], v13 offset:17280
ds_read_b128 a[4:7], v2 offset:0
ds_read_b64_tr_b16 a[172:173], v13 offset:19456
ds_read_b64_tr_b16 a[174:175], v13 offset:20224
ds_read_b64_tr_b16 a[176:177], v13 offset:19520
ds_read_b64_tr_b16 a[178:179], v13 offset:20288
s_waitcnt lgkmcnt(5)
v_mfma_f32_32x32x16_bf16 v[16:31], a[160:163], a[0:3], 0
ds_read_b64_tr_b16 a[180:181], v13 offset:19584
ds_read_b64_tr_b16 a[182:183], v13 offset:20352
ds_read_b128 a[8:11], v3 offset:0
ds_read_b64_tr_b16 v[160:161], v206 offset:0
ds_read_b64_tr_b16 v[162:163], v206 offset:1024
ds_read_b64_tr_b16 v[164:165], v210 offset:0
ds_read_b64_tr_b16 v[166:167], v210 offset:1024
ds_read_b64_tr_b16 v[168:169], v206 offset:4096
ds_read_b64_tr_b16 v[170:171], v206 offset:5120
v_mfma_f32_32x32x16_bf16 v[32:47], a[164:167], a[0:3], 0
ds_read_b64_tr_b16 a[184:185], v13 offset:22528
ds_read_b64_tr_b16 a[186:187], v13 offset:23296
ds_read_b64_tr_b16 a[188:189], v13 offset:22592
ds_read_b64_tr_b16 a[190:191], v13 offset:23360
ds_read_b64_tr_b16 v[172:173], v210 offset:4096
ds_read_b64_tr_b16 v[174:175], v210 offset:5120
ds_read_b64_tr_b16 v[176:177], v208 offset:8192
ds_read_b64_tr_b16 v[178:179], v208 offset:9216
ds_read_b64_tr_b16 v[180:181], v211 offset:8192
v_mfma_f32_32x32x16_bf16 v[48:63], a[168:171], a[0:3], 0
ds_read_b64_tr_b16 a[192:193], v13 offset:22656
ds_read_b64_tr_b16 a[194:195], v13 offset:23424
ds_read_b128 a[12:15], v4 offset:0
ds_read_b64_tr_b16 v[182:183], v211 offset:9216
s_cmp_eq_u32 s40, 2
s_cselect_b32 s56, 0xff000000, 0
s_mov_b32 s57, s56
s_lshl_b32 s48, s40, 10
s_waitcnt lgkmcnt(15)
v_mfma_f32_32x32x16_bf16 v[16:31], a[172:175], a[4:7], v[16:31]
ds_read_b64_tr_b16 a[196:197], v13 offset:25600
ds_read_b64_tr_b16 a[198:199], v13 offset:26368
ds_read_b64_tr_b16 a[200:201], v13 offset:25664
ds_read_b64_tr_b16 a[202:203], v13 offset:26432
s_add_u32 s55, s48, s87
s_lshl_b32 s45, s42, 4
s_add_u32 s45, s45, s41
s_mul_i32 s45, s45, 896
s_add_u32 s45, s45, 14438400
v_mfma_f32_32x32x16_bf16 v[32:47], a[176:179], a[4:7], v[32:47]
ds_read_b64_tr_b16 a[204:205], v13 offset:25728
ds_read_b64_tr_b16 a[206:207], v13 offset:26496
s_lshl_b32 s46, s40, 7
s_add_u32 s46, s46, s45
s_add_u32 s46, s46, 384
s_min_u32 s47, s40, 2
s_lshl_b32 s47, s47, 7
s_add_u32 s47, s47, s45
v_lshlrev_b32 v200, 2, v0
v_mov_b32 v201, 0
v_cndmask_b32 v160, v160, v221, s[56:57]
v_cndmask_b32 v161, v161, v221, s[56:57]
v_cndmask_b32 v162, v162, v221, s[56:57]
v_cndmask_b32 v163, v163, v221, s[56:57]
v_mfma_f32_32x32x16_bf16 v[80:95], v[112:115], v[164:167], 0
buffer_store_dwordx4 v[160:163], v212, s[32:35], s55 offen sc1
v_mfma_f32_32x32x16_bf16 v[64:79], v[112:115], v[160:163], 0
s_waitcnt lgkmcnt(15)
v_cndmask_b32 v168, v168, v221, s[56:57]
v_cndmask_b32 v169, v169, v221, s[56:57]
v_cndmask_b32 v170, v170, v221, s[56:57]
v_cndmask_b32 v171, v171, v221, s[56:57]
s_waitcnt lgkmcnt(13)
v_mfma_f32_32x32x16_bf16 v[80:95], v[112:115], v[172:175], v[80:95]
buffer_store_dwordx4 v[168:171], v213, s[32:35], s55 offen sc1
v_mfma_f32_32x32x16_bf16 v[64:79], v[112:115], v[168:171], v[64:79]
s_waitcnt lgkmcnt(12)
v_cndmask_b32 v176, v176, v221, s[56:57]
v_cndmask_b32 v177, v177, v221, s[56:57]
s_waitcnt lgkmcnt(11)
v_cndmask_b32 v178, v178, v221, s[56:57]
v_cndmask_b32 v179, v179, v221, s[56:57]
s_waitcnt lgkmcnt(6)
v_mfma_f32_32x32x16_bf16 v[80:95], v[116:119], v[180:183], v[80:95]
s_mov_b32 exec_hi, 0
buffer_store_dwordx4 v[176:179], v214, s[32:35], s55 offen sc1
s_mov_b32 exec_hi, -1
v_mfma_f32_32x32x16_bf16 v[64:79], v[116:119], v[176:179], v[64:79]
s_mov_b32 exec_hi, 0
s_nop 6
buffer_store_dword v80, v200, s[32:35], s47 offen sc1
s_nop 2
buffer_store_dword v64, v200, s[32:35], s46 offen sc1
s_mov_b32 exec_hi, -1
buffer_load_dword v219, v201, s[36:39], 0 offen sc1
s_waitcnt vmcnt(20)
s_barrier
ds_read_b128 a[16:19], v1 offset:28672
s_add_u32 s48, s40, 1
s_and_b32 s48, s48, 3
s_mul_i32 s48, s48, 69632
v_add_u32 v253, s48, v232
v_mfma_f32_32x32x16_bf16 v[48:63], a[180:183], a[4:7], v[48:63]
s_add_u32 m0, s61, 114688
s_add_u32 s76, s60, 512
buffer_load_dwordx4 v96, s[4:7], s76 offen offset:0 lds
ds_read_b64_tr_b16 a[208:209], v13 offset:45056
ds_read_b64_tr_b16 a[210:211], v13 offset:45824
ds_read_b64_tr_b16 a[212:213], v13 offset:45120
ds_read_b64_tr_b16 a[214:215], v13 offset:45888
s_add_u32 s48, s40, 2
v_mfma_f32_32x32x16_bf16 v[16:31], a[184:187], a[8:11], v[16:31]
buffer_load_dwordx4 v97, s[4:7], s76 offen offset:1024 lds
ds_read_b64_tr_b16 a[216:217], v13 offset:45184
ds_read_b64_tr_b16 a[218:219], v13 offset:45952
ds_read_b128 a[20:23], v2 offset:28672
s_and_b32 s48, s48, 3
s_mul_i32 s48, s48, 69632
v_add_u32 v250, s48, v232
s_add_u32 s48, s40, 3
s_and_b32 s48, s48, 3
v_mfma_f32_32x32x16_bf16 v[32:47], a[188:191], a[8:11], v[32:47]
buffer_load_dwordx4 v98, s[4:7], s76 offen offset:2048 lds
ds_read_b64_tr_b16 a[220:221], v13 offset:48128
ds_read_b64_tr_b16 a[222:223], v13 offset:48896
ds_read_b64_tr_b16 a[224:225], v13 offset:48192
ds_read_b64_tr_b16 a[226:227], v13 offset:48960
s_mul_i32 s48, s48, 69632
v_add_u32 v251, s48, v232
s_add_u32 s48, s40, 4
s_and_b32 s48, s48, 3
v_mfma_f32_32x32x16_bf16 v[48:63], a[192:195], a[8:11], v[48:63]
buffer_load_dwordx4 v99, s[4:7], s76 offen offset:3072 lds
ds_read_b64_tr_b16 a[228:229], v13 offset:48256
ds_read_b64_tr_b16 a[230:231], v13 offset:49024
s_mul_i32 s48, s48, 69632
v_add_u32 v252, s48, v232
v_add_u32 v249, 4096, v232
s_mul_i32 s48, s43, 278528
s_add_u32 s48, s48, 5480448
s_waitcnt lgkmcnt(14)
v_mfma_f32_32x32x16_bf16 v[16:31], a[196:199], a[12:15], v[16:31]
s_add_u32 m0, s63, 114688
s_add_u32 s77, s62, 786432
buffer_load_dwordx4 v237, s[16:19], s77 offen offset:0 lds
ds_read_b128 a[24:27], v3 offset:28672
ds_read_b64_tr_b16 a[232:233], v13 offset:51200
ds_read_b64_tr_b16 a[234:235], v13 offset:51968
s_mul_i32 s49, s44, 348160
s_add_u32 s49, s49, 2691072
s_mul_i32 s50, s40, 12288
v_mfma_f32_32x32x16_bf16 v[32:47], a[200:203], a[12:15], v[32:47]
ds_read_b64_tr_b16 a[236:237], v13 offset:51264
ds_read_b64_tr_b16 a[238:239], v13 offset:52032
s_add_u32 s79, s48, s50
s_mul_i32 s50, s40, 61440
s_add_u32 s80, s49, s50
s_add_u32 s50, s43, s44
s_and_b32 s50, s50, 0
s_mul_i32 s0, s50, 3
s_mul_i32 s50, s0, 1024
v_mfma_f32_32x32x16_bf16 v[48:63], a[204:207], a[12:15], v[48:63]
buffer_load_dwordx4 v238, s[16:19], s77 offen offset:1024 lds
ds_read_b64_tr_b16 a[240:241], v13 offset:51328
ds_read_b64_tr_b16 a[242:243], v13 offset:52096
s_add_u32 s79, s79, s50
s_sub_u32 s1, s79, 12288
s_mul_i32 s50, s0, 5120
s_add_u32 s80, s80, s50
s_sub_u32 s87, s80, 61440
s_waitcnt lgkmcnt(14)
v_mfma_f32_32x32x16_bf16 v[16:31], a[208:211], a[16:19], v[16:31]
ds_read_b128 a[28:31], v4 offset:28672
ds_read_b64_tr_b16 a[244:245], v13 offset:54272
ds_read_b64_tr_b16 a[246:247], v13 offset:55040
s_mul_i32 s50, s40, 5120
s_add_u32 s48, s48, 49152
s_add_u32 s81, s48, s50
s_mul_i32 s50, s40, 25600
s_add_u32 s49, s49, 245760
s_add_u32 s82, s49, s50
v_mfma_f32_32x32x16_bf16 v[32:47], a[212:215], a[16:19], v[32:47]
buffer_load_dwordx4 v239, s[16:19], s77 offen offset:2048 lds
ds_read_b64_tr_b16 a[248:249], v13 offset:54336
ds_read_b64_tr_b16 a[250:251], v13 offset:55104
s_lshl_b32 s48, s43, 2
s_add_u32 s48, s48, s40
s_mul_i32 s48, s48, 20480
s_mul_i32 s49, s44, 160
s_add_u32 s83, s48, s49
v_mfma_f32_32x32x16_bf16 v[48:63], a[216:219], a[16:19], v[48:63]
s_mul_i32 s84, s43, 61440
s_mul_i32 s76, s44, 160
s_add_u32 s77, s84, s76
s_lshl_b32 s85, s40, 10
s_add_u32 m0, s85, 143360
s_nop 0
buffer_load_dwordx4 v100, s[24:27], s77 offen lds
s_waitcnt lgkmcnt(12)
v_mfma_f32_32x32x16_bf16 v[16:31], a[220:223], a[20:23], v[16:31]
ds_read_b64_tr_b16 a[252:253], v13 offset:54400
ds_read_b64_tr_b16 a[254:255], v13 offset:55168
s_waitcnt vmcnt(8)
s_barrier
v_readfirstlane_b32 s58, v219
s_nop 0
s_cmp_lg_u32 s58, 0
s_cbranch_scc0 L_fb_dbg
L_ok_dbg:
buffer_store_dword v255, v254, s[32:35], 0 offen sc1
ds_read_b128 a[32:35], v5 offset:0
v_mfma_f32_32x32x16_bf16 v[32:47], a[224:227], a[20:23], v[32:47]
ds_read_b64_tr_b16 a[160:161], v14 offset:16384
ds_read_b64_tr_b16 a[162:163], v14 offset:17152
ds_read_b64_tr_b16 a[164:165], v14 offset:16448
ds_read_b64_tr_b16 a[166:167], v14 offset:17216
v_mfma_f32_32x32x16_bf16 v[48:63], a[228:231], a[20:23], v[48:63]
s_add_u32 m0, s85, 147456
s_nop 0
buffer_load_dwordx4 v101, s[24:27], s77 offen lds
ds_read_b64_tr_b16 a[168:169], v14 offset:16512
ds_read_b64_tr_b16 a[170:171], v14 offset:17280
s_waitcnt lgkmcnt(14)
v_mfma_f32_32x32x16_bf16 v[16:31], a[232:235], a[24:27], v[16:31]
ds_read_b128 a[36:39], v6 offset:0
ds_read_b64_tr_b16 a[172:173], v14 offset:19456
ds_read_b64_tr_b16 a[174:175], v14 offset:20224
v_mfma_f32_32x32x16_bf16 v[32:47], a[236:239], a[24:27], v[32:47]
s_lshr_b32 s84, s43, 1
s_mul_i32 s84, s84, 51200
s_add_u32 s77, s84, s76
s_add_u32 m0, s85, 151552
s_nop 0
buffer_load_dwordx4 v102, s[12:15], s77 offen lds
ds_read_b64_tr_b16 a[176:177], v14 offset:19520
ds_read_b64_tr_b16 a[178:179], v14 offset:20288
v_mfma_f32_32x32x16_bf16 v[48:63], a[240:243], a[24:27], v[48:63]
ds_read_b64_tr_b16 a[180:181], v14 offset:19584
ds_read_b64_tr_b16 a[182:183], v14 offset:20352
s_waitcnt lgkmcnt(14)
v_mfma_f32_32x32x16_bf16 v[16:31], a[244:247], a[28:31], v[16:31]
ds_read_b128 a[40:43], v7 offset:0
ds_read_b64_tr_b16 a[184:185], v14 offset:22528
ds_read_b64_tr_b16 a[186:187], v14 offset:23296
v_mfma_f32_32x32x16_bf16 v[32:47], a[248:251], a[28:31], v[32:47]
s_add_u32 m0, s85, 155648
s_nop 0
buffer_load_dwordx4 v103, s[12:15], s77 offen lds
ds_read_b64_tr_b16 a[188:189], v14 offset:22592
ds_read_b64_tr_b16 a[190:191], v14 offset:23360
v_mfma_f32_32x32x16_bf16 v[48:63], a[252:255], a[28:31], v[48:63]
ds_read_b64_tr_b16 a[192:193], v14 offset:22656
ds_read_b64_tr_b16 a[194:195], v14 offset:23424
s_waitcnt lgkmcnt(14)
v_mfma_f32_32x32x16_bf16 v[16:31], a[160:163], a[32:35], v[16:31]
s_add_u32 m0, s61, 0
s_add_u32 s76, s60, 640
buffer_load_dwordx4 v96, s[4:7], s76 offen offset:0 lds
ds_read_b128 a[44:47], v8 offset:0
ds_read_b64_tr_b16 a[196:197], v14 offset:25600
ds_read_b64_tr_b16 a[198:199], v14 offset:26368
v_mfma_f32_32x32x16_bf16 v[32:47], a[164:167], a[32:35], v[32:47]
buffer_load_dwordx4 v97, s[4:7], s76 offen offset:1024 lds
ds_read_b64_tr_b16 a[200:201], v14 offset:25664
ds_read_b64_tr_b16 a[202:203], v14 offset:26432
v_mfma_f32_32x32x16_bf16 v[48:63], a[168:171], a[32:35], v[48:63]
ds_read_b64_tr_b16 a[204:205], v14 offset:25728
ds_read_b64_tr_b16 a[206:207], v14 offset:26496
s_waitcnt lgkmcnt(14)
v_mfma_f32_32x32x16_bf16 v[16:31], a[172:175], a[36:39], v[16:31]
s_barrier
buffer_load_dwordx4 v98, s[4:7], s76 offen offset:2048 lds
ds_read_b128 a[48:51], v5 offset:28672
ds_read_b64_tr_b16 a[208:209], v14 offset:45056
ds_read_b64_tr_b16 a[210:211], v14 offset:45824
v_mfma_f32_32x32x16_bf16 v[32:47], a[176:179], a[36:39], v[32:47]
buffer_load_dwordx4 v99, s[4:7], s76 offen offset:3072 lds
ds_read_b64_tr_b16 a[212:213], v14 offset:45120
ds_read_b64_tr_b16 a[214:215], v14 offset:45888
v_mfma_f32_32x32x16_bf16 v[48:63], a[180:183], a[36:39], v[48:63]
s_add_u32 m0, s63, 0
s_add_u32 s77, s62, 983040
buffer_load_dwordx4 v237, s[16:19], s77 offen offset:0 lds
ds_read_b64_tr_b16 a[216:217], v14 offset:45184
ds_read_b64_tr_b16 a[218:219], v14 offset:45952
s_waitcnt lgkmcnt(14)
v_mfma_f32_32x32x16_bf16 v[16:31], a[184:187], a[40:43], v[16:31]
ds_read_b128 a[52:55], v6 offset:28672
ds_read_b64_tr_b16 a[220:221], v14 offset:48128
ds_read_b64_tr_b16 a[222:223], v14 offset:48896
v_mfma_f32_32x32x16_bf16 v[32:47], a[188:191], a[40:43], v[32:47]
buffer_load_dwordx4 v238, s[16:19], s77 offen offset:1024 lds
ds_read_b64_tr_b16 a[224:225], v14 offset:48192
ds_read_b64_tr_b16 a[226:227], v14 offset:48960
v_mfma_f32_32x32x16_bf16 v[48:63], a[192:195], a[40:43], v[48:63]
ds_read_b64_tr_b16 a[228:229], v14 offset:48256
ds_read_b64_tr_b16 a[230:231], v14 offset:49024
s_waitcnt lgkmcnt(14)
v_mfma_f32_32x32x16_bf16 v[16:31], a[196:199], a[44:47], v[16:31]
buffer_load_dwordx4 v239, s[16:19], s77 offen offset:2048 lds
ds_read_b128 a[56:59], v7 offset:28672
ds_read_b64_tr_b16 a[232:233], v14 offset:51200
ds_read_b64_tr_b16 a[234:235], v14 offset:51968
v_mfma_f32_32x32x16_bf16 v[32:47], a[200:203], a[44:47], v[32:47]
ds_read_b64_tr_b16 a[236:237], v14 offset:51264
ds_read_b64_tr_b16 a[238:239], v14 offset:52032
v_mfma_f32_32x32x16_bf16 v[48:63], a[204:207], a[44:47], v[48:63]
s_add_u32 m0, s61, 28672
s_add_u32 s76, s60, 768
buffer_load_dwordx4 v96, s[4:7], s76 offen offset:0 lds
ds_read_b64_tr_b16 a[240:241], v14 offset:51328
ds_read_b64_tr_b16 a[242:243], v14 offset:52096
s_waitcnt lgkmcnt(14)
v_mfma_f32_32x32x16_bf16 v[16:31], a[208:211], a[48:51], v[16:31]
buffer_load_dwordx4 v97, s[4:7], s76 offen offset:1024 lds
ds_read_b128 a[60:63], v8 offset:28672
ds_read_b64_tr_b16 a[244:245], v14 offset:54272
ds_read_b64_tr_b16 a[246:247], v14 offset:55040
v_mfma_f32_32x32x16_bf16 v[32:47], a[212:215], a[48:51], v[32:47]
buffer_load_dwordx4 v98, s[4:7], s76 offen offset:2048 lds
ds_read_b64_tr_b16 a[248:249], v14 offset:54336
ds_read_b64_tr_b16 a[250:251], v14 offset:55104
v_mfma_f32_32x32x16_bf16 v[48:63], a[216:219], a[48:51], v[48:63]
buffer_load_dwordx4 v99, s[4:7], s76 offen offset:3072 lds
ds_read_b64_tr_b16 a[252:253], v14 offset:54400
ds_read_b64_tr_b16 a[254:255], v14 offset:55168
s_waitcnt lgkmcnt(14)
v_mfma_f32_32x32x16_bf16 v[16:31], a[220:223], a[52:55], v[16:31]
s_waitcnt vmcnt(16)
s_barrier
ds_read_b128 a[64:67], v9 offset:0
ds_read_b64_tr_b16 a[160:161], v15 offset:16384
ds_read_b64_tr_b16 a[162:163], v15 offset:17152
v_mfma_f32_32x32x16_bf16 v[32:47], a[224:227], a[52:55], v[32:47]
s_add_u32 m0, s63, 28672
s_add_u32 s77, s62, 1179648
buffer_load_dwordx4 v237, s[16:19], s77 offen offset:0 lds
ds_read_b64_tr_b16 a[164:165], v15 offset:16448
ds_read_b64_tr_b16 a[166:167], v15 offset:17216
v_mfma_f32_32x32x16_bf16 v[48:63], a[228:231], a[52:55], v[48:63]
ds_read_b64_tr_b16 a[168:169], v15 offset:16512
ds_read_b64_tr_b16 a[170:171], v15 offset:17280
s_waitcnt lgkmcnt(14)
v_mfma_f32_32x32x16_bf16 v[16:31], a[232:235], a[56:59], v[16:31]
buffer_load_dwordx4 v238, s[16:19], s77 offen offset:1024 lds
ds_read_b128 a[68:71], v10 offset:0
ds_read_b64_tr_b16 a[172:173], v15 offset:19456
ds_read_b64_tr_b16 a[174:175], v15 offset:20224
v_mfma_f32_32x32x16_bf16 v[32:47], a[236:239], a[56:59], v[32:47]
buffer_load_dwordx4 v239, s[16:19], s77 offen offset:2048 lds
ds_read_b64_tr_b16 a[176:177], v15 offset:19520
ds_read_b64_tr_b16 a[178:179], v15 offset:20288
v_mfma_f32_32x32x16_bf16 v[48:63], a[240:243], a[56:59], v[48:63]
ds_read_b64_tr_b16 a[180:181], v15 offset:19584
ds_read_b64_tr_b16 a[182:183], v15 offset:20352
s_waitcnt lgkmcnt(14)
v_mfma_f32_32x32x16_bf16 v[16:31], a[244:247], a[60:63], v[16:31]
s_add_u32 m0, s61, 57344
s_add_u32 s76, s60, 896
buffer_load_dwordx4 v96, s[4:7], s76 offen offset:0 lds
ds_read_b128 a[72:75], v11 offset:0
ds_read_b64_tr_b16 a[184:185], v15 offset:22528
ds_read_b64_tr_b16 a[186:187], v15 offset:23296
v_mfma_f32_32x32x16_bf16 v[32:47], a[248:251], a[60:63], v[32:47]
buffer_load_dwordx4 v97, s[4:7], s76 offen offset:1024 lds
ds_read_b64_tr_b16 a[188:189], v15 offset:22592
ds_read_b64_tr_b16 a[190:191], v15 offset:23360
v_mfma_f32_32x32x16_bf16 v[48:63], a[252:255], a[60:63], v[48:63]
ds_read_b64_tr_b16 a[192:193], v15 offset:22656
ds_read_b64_tr_b16 a[194:195], v15 offset:23424
s_waitcnt lgkmcnt(14)
v_mfma_f32_32x32x16_bf16 v[16:31], a[160:163], a[64:67], v[16:31]
buffer_load_dwordx4 v98, s[4:7], s76 offen offset:2048 lds
ds_read_b128 a[76:79], v12 offset:0
ds_read_b64_tr_b16 a[196:197], v15 offset:25600
ds_read_b64_tr_b16 a[198:199], v15 offset:26368
v_mfma_f32_32x32x16_bf16 v[32:47], a[164:167], a[64:67], v[32:47]
buffer_load_dwordx4 v99, s[4:7], s76 offen offset:3072 lds
ds_read_b64_tr_b16 a[200:201], v15 offset:25664
ds_read_b64_tr_b16 a[202:203], v15 offset:26432
v_mfma_f32_32x32x16_bf16 v[48:63], a[168:171], a[64:67], v[48:63]
s_add_u32 m0, s63, 57344
s_add_u32 s77, s62, 1376256
buffer_load_dwordx4 v237, s[16:19], s77 offen offset:0 lds
ds_read_b64_tr_b16 a[204:205], v15 offset:25728
ds_read_b64_tr_b16 a[206:207], v15 offset:26496
s_waitcnt lgkmcnt(14)
v_mfma_f32_32x32x16_bf16 v[16:31], a[172:175], a[68:71], v[16:31]
s_waitcnt vmcnt(12)
s_barrier
buffer_load_dword v217, v216, s[32:35], 0 offen sc1
ds_read_b64_tr_b16 v[112:113], v124
ds_read_b64_tr_b16 v[114:115], v124 offset:1280
ds_read_b64_tr_b16 v[116:117], v125
ds_read_b64_tr_b16 v[118:119], v125 offset:1280
ds_read_b64_tr_b16 v[120:121], v126
ds_read_b64_tr_b16 v[122:123], v126 offset:1280
v_mfma_f32_32x32x16_bf16 v[32:47], a[176:179], a[68:71], v[32:47]
buffer_load_dwordx4 v238, s[16:19], s77 offen offset:1024 lds
ds_read_b128 a[80:83], v1 offset:0
ds_read_b64_tr_b16 a[208:209], v13 offset:16384
ds_read_b64_tr_b16 a[210:211], v13 offset:17152
v_mfma_f32_32x32x16_bf16 v[48:63], a[180:183], a[68:71], v[48:63]
ds_read_b64_tr_b16 a[212:213], v13 offset:16448
ds_read_b64_tr_b16 a[214:215], v13 offset:17216
ds_read_b64_tr_b16 a[216:217], v13 offset:16512
ds_read_b64_tr_b16 a[218:219], v13 offset:17280
s_waitcnt lgkmcnt(15)
v_mfma_f32_32x32x16_bf16 v[16:31], a[184:187], a[72:75], v[16:31]
buffer_load_dwordx4 v239, s[16:19], s77 offen offset:2048 lds
ds_read_b128 a[84:87], v2 offset:0
ds_read_b64_tr_b16 a[220:221], v13 offset:19456
ds_read_b64_tr_b16 a[222:223], v13 offset:20224
v_mfma_f32_32x32x16_bf16 v[32:47], a[188:191], a[72:75], v[32:47]
ds_read_b64_tr_b16 a[224:225], v13 offset:19520
ds_read_b64_tr_b16 a[226:227], v13 offset:20288
v_mfma_f32_32x32x16_bf16 v[48:63], a[192:195], a[72:75], v[48:63]
s_add_u32 m0, s61, 86016
s_add_u32 s76, s60, 1024
buffer_load_dwordx4 v96, s[4:7], s76 offen offset:0 lds
ds_read_b64_tr_b16 a[228:229], v13 offset:19584
ds_read_b64_tr_b16 a[230:231], v13 offset:20352
s_waitcnt lgkmcnt(15)
v_mfma_f32_32x32x16_bf16 v[16:31], a[196:199], a[76:79], v[16:31]
buffer_load_dwordx4 v97, s[4:7], s76 offen offset:1024 lds
ds_read_b128 a[88:91], v3 offset:0
ds_read_b64_tr_b16 a[232:233], v13 offset:22528
ds_read_b64_tr_b16 a[234:235], v13 offset:23296
v_mfma_f32_32x32x16_bf16 v[32:47], a[200:203], a[76:79], v[32:47]
ds_read_b64_tr_b16 a[236:237], v13 offset:22592
ds_read_b64_tr_b16 a[238:239], v13 offset:23360
v_mfma_f32_32x32x16_bf16 v[48:63], a[204:207], a[76:79], v[48:63]
buffer_load_dwordx4 v98, s[4:7], s76 offen offset:2048 lds
ds_read_b64_tr_b16 a[240:241], v13 offset:22656
ds_read_b64_tr_b16 a[242:243], v13 offset:23424
s_waitcnt lgkmcnt(14)
v_mfma_f32_32x32x16_bf16 v[16:31], a[208:211], a[80:83], v[16:31]
buffer_load_dwordx4 v99, s[4:7], s76 offen offset:3072 lds
ds_read_b128 a[92:95], v4 offset:0
ds_read_b64_tr_b16 a[244:245], v13 offset:25600
ds_read_b64_tr_b16 a[246:247], v13 offset:26368
v_mfma_f32_32x32x16_bf16 v[32:47], a[212:215], a[80:83], v[32:47]
s_add_u32 m0, s63, 86016
s_add_u32 s77, s62, 1572864
buffer_load_dwordx4 v237, s[16:19], s77 offen offset:0 lds
ds_read_b64_tr_b16 a[248:249], v13 offset:25664
ds_read_b64_tr_b16 a[250:251], v13 offset:26432
v_mfma_f32_32x32x16_bf16 v[48:63], a[216:219], a[80:83], v[48:63]
ds_read_b64_tr_b16 a[252:253], v13 offset:25728
ds_read_b64_tr_b16 a[254:255], v13 offset:26496
s_waitcnt lgkmcnt(14)
v_mfma_f32_32x32x16_bf16 v[16:31], a[220:223], a[84:87], v[16:31]
s_waitcnt vmcnt(13)
s_barrier
s_waitcnt vmcnt(7)
v_cmp_ne_u32 s[58:59], 0, v217
s_nop 1
s_cmp_eq_u64 s[58:59], -1
s_cbranch_scc0 L_fb_h1
L_ok_h1:
buffer_load_dwordx4 v238, s[16:19], s77 offen offset:1024 lds
ds_read_b128 a[96:99], v1 offset:28672
v_mfma_f32_32x32x16_bf16 v[32:47], a[224:227], a[84:87], v[32:47]
ds_read_b64_tr_b16 a[160:161], v13 offset:45056
ds_read_b64_tr_b16 a[162:163], v13 offset:45824
ds_read_b64_tr_b16 a[164:165], v13 offset:45120
ds_read_b64_tr_b16 a[166:167], v13 offset:45888
v_mfma_f32_32x32x16_bf16 v[48:63], a[228:231], a[84:87], v[48:63]
buffer_load_dwordx4 v239, s[16:19], s77 offen offset:2048 lds
ds_read_b64_tr_b16 a[168:169], v13 offset:45184
ds_read_b64_tr_b16 a[170:171], v13 offset:45952
s_waitcnt lgkmcnt(14)
v_mfma_f32_32x32x16_bf16 v[16:31], a[232:235], a[88:91], v[16:31]
s_mul_i32 s84, s44, 348160
s_add_u32 s84, s84, 2691072
buffer_store_dwordx4 v[112:115], v127, s[32:35], s84 offen sc1
ds_read_b128 a[100:103], v2 offset:28672
ds_read_b64_tr_b16 a[172:173], v13 offset:48128
ds_read_b64_tr_b16 a[174:175], v13 offset:48896
v_mfma_f32_32x32x16_bf16 v[32:47], a[236:239], a[88:91], v[32:47]
ds_read_b64_tr_b16 a[176:177], v13 offset:48192
ds_read_b64_tr_b16 a[178:179], v13 offset:48960
v_mfma_f32_32x32x16_bf16 v[48:63], a[240:243], a[88:91], v[48:63]
ds_read_b64_tr_b16 a[180:181], v13 offset:48256
ds_read_b64_tr_b16 a[182:183], v13 offset:49024
s_waitcnt lgkmcnt(14)
v_mfma_f32_32x32x16_bf16 v[16:31], a[244:247], a[92:95], v[16:31]
ds_read_b128 a[104:107], v3 offset:28672
ds_read_b64_tr_b16 a[184:185], v13 offset:51200
ds_read_b64_tr_b16 a[186:187], v13 offset:51968
v_mfma_f32_32x32x16_bf16 v[32:47], a[248:251], a[92:95], v[32:47]
buffer_store_dwordx4 v[116:119], v235, s[32:35], s84 offen sc1
ds_read_b64_tr_b16 a[188:189], v13 offset:51264
ds_read_b64_tr_b16 a[190:191], v13 offset:52032
v_mfma_f32_32x32x16_bf16 v[48:63], a[252:255], a[92:95], v[48:63]
ds_read_b64_tr_b16 a[192:193], v13 offset:51328
ds_read_b64_tr_b16 a[194:195], v13 offset:52096
s_waitcnt lgkmcnt(14)
v_mfma_f32_32x32x16_bf16 v[16:31], a[160:163], a[96:99], v[16:31]
ds_read_b128 a[108:111], v4 offset:28672
ds_read_b64_tr_b16 a[196:197], v13 offset:54272
ds_read_b64_tr_b16 a[198:199], v13 offset:55040
v_mfma_f32_32x32x16_bf16 v[32:47], a[164:167], a[96:99], v[32:47]
ds_read_b64_tr_b16 a[200:201], v13 offset:54336
ds_read_b64_tr_b16 a[202:203], v13 offset:55104
v_mfma_f32_32x32x16_bf16 v[48:63], a[168:171], a[96:99], v[48:63]
buffer_store_dwordx4 v[120:123], v236, s[32:35], s84 offen sc1
ds_read_b64_tr_b16 a[204:205], v13 offset:54400
ds_read_b64_tr_b16 a[206:207], v13 offset:55168
s_waitcnt lgkmcnt(14)
v_mfma_f32_32x32x16_bf16 v[16:31], a[172:175], a[100:103], v[16:31]
s_waitcnt vmcnt(10)
s_barrier
ds_read_b128 a[112:115], v5 offset:0
ds_read_b64_tr_b16 a[208:209], v14 offset:16384
ds_read_b64_tr_b16 a[210:211], v14 offset:17152
v_mfma_f32_32x32x16_bf16 v[32:47], a[176:179], a[100:103], v[32:47]
ds_read_b64_tr_b16 a[212:213], v14 offset:16448
ds_read_b64_tr_b16 a[214:215], v14 offset:17216
v_mfma_f32_32x32x16_bf16 v[48:63], a[180:183], a[100:103], v[48:63]
v_min_u32 v197, 55, v0
v_lshlrev_b32 v198, 4, v197
s_lshl_b32 s84, s42, 2
s_add_u32 s84, s84, s40
s_mul_i32 s84, s84, 3584
s_add_u32 s84, s84, 14438400
buffer_load_dwordx4 v[200:203], v198, s[32:35], s84 offen offset:0 sc1
s_waitcnt lgkmcnt(12)
v_mfma_f32_32x32x16_bf16 v[16:31], a[184:187], a[104:107], v[16:31]
buffer_load_dwordx4 v[204:207], v198, s[32:35], s84 offen offset:896 sc1
ds_read_b64_tr_b16 a[216:217], v14 offset:16512
ds_read_b64_tr_b16 a[218:219], v14 offset:17280
ds_read_b128 a[116:119], v6 offset:0
v_mfma_f32_32x32x16_bf16 v[32:47], a[188:191], a[104:107], v[32:47]
buffer_load_dwordx4 v[208:211], v198, s[32:35], s84 offen offset:1792 sc1
ds_read_b64_tr_b16 a[220:221], v14 offset:19456
ds_read_b64_tr_b16 a[222:223], v14 offset:20224
ds_read_b64_tr_b16 a[224:225], v14 offset:19520
ds_read_b64_tr_b16 a[226:227], v14 offset:20288
v_mfma_f32_32x32x16_bf16 v[48:63], a[192:195], a[104:107], v[48:63]
buffer_load_dwordx4 v[212:215], v198, s[32:35], s84 offen offset:2688 sc1
ds_read_b64_tr_b16 a[228:229], v14 offset:19584
ds_read_b64_tr_b16 a[230:231], v14 offset:20352
s_waitcnt lgkmcnt(14)
v_mfma_f32_32x32x16_bf16 v[16:31], a[196:199], a[108:111], v[16:31]
ds_read_b128 a[120:123], v7 offset:0
ds_read_b64_tr_b16 a[232:233], v14 offset:22528
ds_read_b64_tr_b16 a[234:235], v14 offset:23296
v_mfma_f32_32x32x16_bf16 v[32:47], a[200:203], a[108:111], v[32:47]
v_and_b32 v196, 31, v0
v_lshlrev_b32 v197, 4, v196
s_lshl_b32 s84, s71, 4
s_add_u32 s84, s84, 14397440
buffer_load_dwordx4 v[128:131], v197, s[32:35], s84 offen sc1
v_mfma_f32_32x32x16_bf16 v[48:63], a[204:207], a[108:111], v[48:63]
v_lshrrev_b32 v197, 5, v0
v_lshlrev_b32 v197, 4, v197
s_lshl_b32 s84, s71, 2
s_add_u32 s84, s84, 14430208
buffer_load_dwordx4 v[136:139], v197, s[32:35], s84 offen offset:0 sc1
s_waitcnt lgkmcnt(10)
v_mfma_f32_32x32x16_bf16 v[16:31], a[208:211], a[112:115], v[16:31]
buffer_load_dwordx4 v[140:143], v197, s[32:35], s84 offen offset:32 sc1
ds_read_b64_tr_b16 a[236:237], v14 offset:22592
ds_read_b64_tr_b16 a[238:239], v14 offset:23360
ds_read_b64_tr_b16 a[240:241], v14 offset:22656
ds_read_b64_tr_b16 a[242:243], v14 offset:23424
v_mfma_f32_32x32x16_bf16 v[32:47], a[212:215], a[112:115], v[32:47]
buffer_load_dwordx4 v[144:147], v197, s[32:35], s84 offen offset:64 sc1
buffer_load_dwordx4 v[148:151], v197, s[32:35], s84 offen offset:96 sc1
v_lshlrev_b32 v196, 1, v196
s_mul_i32 s84, s42, 192
buffer_load_ushort v216, v196, s[20:23], s84 offen offset:0
buffer_load_ushort v217, v196, s[20:23], s84 offen offset:64
buffer_load_ushort v218, v196, s[20:23], s84 offen offset:128
s_add_u32 m0, s61, 114688
s_add_u32 s76, s60, 1152
buffer_load_dwordx4 v96, s[4:7], s76 offen offset:0 lds
ds_read_b128 a[124:127], v8 offset:0
ds_read_b64_tr_b16 a[244:245], v14 offset:25600
ds_read_b64_tr_b16 a[246:247], v14 offset:26368
v_mfma_f32_32x32x16_bf16 v[48:63], a[216:219], a[112:115], v[48:63]
buffer_load_dwordx4 v97, s[4:7], s76 offen offset:1024 lds
ds_read_b64_tr_b16 a[248:249], v14 offset:25664
ds_read_b64_tr_b16 a[250:251], v14 offset:26432
ds_read_b64_tr_b16 a[252:253], v14 offset:25728
ds_read_b64_tr_b16 a[254:255], v14 offset:26496
s_waitcnt lgkmcnt(14)
v_mfma_f32_32x32x16_bf16 v[16:31], a[220:223], a[116:119], v[16:31]
s_waitcnt vmcnt(14)
s_barrier
s_lshl_b32 s58, s44, 5
s_add_u32 s58, s58, s43
s_lshl_b32 s58, s58, 2
s_add_u32 s58, s58, 4096
s_cmp_eq_u32 s40, 0
s_cselect_b32 s58, s58, 0x40000000
v_mov_b32 v236, 0x40000000
v_writelane_b32 v236, s58, 0
buffer_store_dword v255, v236, s[32:35], 0 offen sc1
s_lshl_b32 s58, s44, 7
s_add_u32 s58, s58, 4096
v_and_b32 v235, 31, v0
v_lshl_add_u32 v235, v235, 2, s58
v_mov_b32 v255, 3
v_mfma_f32_32x32x16_bf16 v[32:47], a[224:227], a[116:119], v[32:47]
buffer_load_dwordx4 v98, s[4:7], s76 offen offset:2048 lds
ds_read_b128 a[128:131], v5 offset:28672
ds_read_b64_tr_b16 a[160:161], v14 offset:45056
ds_read_b64_tr_b16 a[162:163], v14 offset:45824
s_waitcnt vmcnt(14)
v_add_f32 v200, v200, v204
v_add_f32 v201, v201, v205
v_mfma_f32_32x32x16_bf16 v[48:63], a[228:231], a[116:119], v[48:63]
buffer_load_dwordx4 v99, s[4:7], s76 offen offset:3072 lds
ds_read_b64_tr_b16 a[164:165], v14 offset:45120
ds_read_b64_tr_b16 a[166:167], v14 offset:45888
ds_read_b64_tr_b16 a[168:169], v14 offset:45184
ds_read_b64_tr_b16 a[170:171], v14 offset:45952
s_waitcnt lgkmcnt(14)
v_mfma_f32_32x32x16_bf16 v[16:31], a[232:235], a[120:123], v[16:31]
s_add_u32 m0, s63, 114688
s_add_u32 s77, s62, 1769472
buffer_load_dwordx4 v237, s[16:19], s77 offen offset:0 lds
ds_read_b128 a[132:135], v6 offset:28672
ds_read_b64_tr_b16 a[172:173], v14 offset:48128
ds_read_b64_tr_b16 a[174:175], v14 offset:48896
v_mfma_f32_32x32x16_bf16 v[32:47], a[236:239], a[120:123], v[32:47]
ds_read_b64_tr_b16 a[176:177], v14 offset:48192
ds_read_b64_tr_b16 a[178:179], v14 offset:48960
v_add_f32 v202, v202, v206
v_add_f32 v203, v203, v207
s_waitcnt vmcnt(14)
v_add_f32 v208, v208, v212
v_add_f32 v209, v209, v213
v_mfma_f32_32x32x16_bf16 v[48:63], a[240:243], a[120:123], v[48:63]
buffer_load_dwordx4 v238, s[16:19], s77 offen offset:1024 lds
ds_read_b64_tr_b16 a[180:181], v14 offset:48256
ds_read_b64_tr_b16 a[182:183], v14 offset:49024
v_add_f32 v210, v210, v214
v_add_f32 v211, v211, v215
s_waitcnt lgkmcnt(14)
v_mfma_f32_32x32x16_bf16 v[16:31], a[244:247], a[124:127], v[16:31]
buffer_load_dwordx4 v239, s[16:19], s77 offen offset:2048 lds
ds_read_b128 a[136:139], v7 offset:28672
ds_read_b64_tr_b16 a[184:185], v14 offset:51200
ds_read_b64_tr_b16 a[186:187], v14 offset:51968
v_add_f32 v200, v200, v208
v_add_f32 v201, v201, v209
v_mfma_f32_32x32x16_bf16 v[32:47], a[248:251], a[124:127], v[32:47]
ds_read_b64_tr_b16 a[188:189], v14 offset:51264
ds_read_b64_tr_b16 a[190:191], v14 offset:52032
v_add_f32 v202, v202, v210
v_add_f32 v203, v203, v211
s_mul_i32 s48, s40, 896
s_add_u32 s48, s48, 159744
v_mfma_f32_32x32x16_bf16 v[48:63], a[252:255], a[124:127], v[48:63]
s_add_u32 m0, s65, 0
s_add_u32 s78, s64, 0
buffer_load_dwordx4 v232, s[32:35], s78 offen offset:0 sc1 lds
ds_read_b64_tr_b16 a[192:193], v14 offset:51328
ds_read_b64_tr_b16 a[194:195], v14 offset:52096
s_waitcnt lgkmcnt(14)
v_mfma_f32_32x32x16_bf16 v[16:31], a[160:163], a[128:131], v[16:31]
ds_read_b128 a[140:143], v8 offset:28672
ds_read_b64_tr_b16 a[196:197], v14 offset:54272
ds_read_b64_tr_b16 a[198:199], v14 offset:55040
v_add_u32 v198, s48, v198
ds_write_b128 v198, v[200:203]
v_and_b32 v196, 31, v0
v_mfma_f32_32x32x16_bf16 v[32:47], a[164:167], a[128:131], v[32:47]
buffer_load_dwordx4 v232, s[32:35], s78 offen offset:1024 sc1 lds
ds_read_b64_tr_b16 a[200:201], v14 offset:54336
ds_read_b64_tr_b16 a[202:203], v14 offset:55104
v_lshlrev_b32 v196, 2, v196
v_add_u32 v196, 159744, v196
s_waitcnt vmcnt(17)
v_mov_b32 v132, v131
v_mfma_f32_32x32x16_bf16 v[48:63], a[168:171], a[128:131], v[48:63]
buffer_load_dwordx4 v232, s[32:35], s78 offen offset:2048 sc1 lds
ds_read_b64_tr_b16 a[204:205], v14 offset:54400
ds_read_b64_tr_b16 a[206:207], v14 offset:55168
v_mov_b32 v131, 0
v_mul_f32 v133, 0x3fb8aa3b, v132
s_waitcnt lgkmcnt(15)
v_mfma_f32_32x32x16_bf16 v[16:31], a[172:175], a[132:135], v[16:31]
v_mul_f32 v134, -2.0, v132
v_cmp_gt_u32 vcc, 32, v0
v_mov_b32 v198, 0
s_nop 0
v_cndmask_b32 v197, 0, 1.0, vcc
s_mov_b32 s48, 0xff000000
s_mov_b32 s49, 0
v_cndmask_b32 v199, 0, 1.0, s[48:49]
s_waitcnt vmcnt(13)
v_lshlrev_b32 v216, 16, v216
v_mul_f32 v216, v216, v197
s_waitcnt vmcnt(12)
v_lshlrev_b32 v217, 16, v217
v_mul_f32 v217, v217, v197
s_waitcnt vmcnt(11)
v_lshlrev_b32 v218, 16, v218
v_mul_f32 v218, v218, v197
s_waitcnt vmcnt(3) lgkmcnt(4)
s_barrier
buffer_load_dwordx4 v232, s[32:35], s78 offen offset:3072 sc1 lds
ds_read_b128 a[144:147], v9 offset:0
ds_read_b64_tr_b16 a[208:209], v15 offset:16384
ds_read_b64_tr_b16 a[210:211], v15 offset:17152
v_mfma_f32_32x32x16_bf16 v[32:47], a[176:179], a[132:135], v[32:47]
s_add_u32 m0, s65, 4096
s_add_u32 s78, s78, 4096
buffer_load_dwordx4 v232, s[32:35], s78 offen offset:0 sc1 lds
ds_read_b64_tr_b16 a[212:213], v15 offset:16448
ds_read_b64_tr_b16 a[214:215], v15 offset:17216
ds_read_b32 v168, v196 offset:0
v_mfma_f32_32x32x16_bf16 v[48:63], a[180:183], a[132:135], v[48:63]
ds_read_b64_tr_b16 a[216:217], v15 offset:16512
ds_read_b64_tr_b16 a[218:219], v15 offset:17280
ds_read_b32 v169, v196 offset:896
ds_read_b32 v170, v196 offset:1792
ds_read_b32 v171, v196 offset:2688
v_mfma_f32_32x32x16_bf16 v[16:31], a[184:187], a[136:139], v[16:31]
buffer_load_dwordx4 v232, s[32:35], s78 offen offset:1024 sc1 lds
ds_read_b128 a[148:151], v10 offset:0
ds_read_b64_tr_b16 a[220:221], v15 offset:19456
ds_read_b64_tr_b16 a[222:223], v15 offset:20224
ds_read_b32 v172, v196 offset:128
ds_read_b32 v173, v196 offset:1024
v_mfma_f32_32x32x16_bf16 v[32:47], a[188:191], a[136:139], v[32:47]
s_add_u32 m0, s65, 28672
s_add_u32 s78, s64, 24576
buffer_load_dwordx4 v232, s[32:35], s78 offen offset:0 sc1 lds
ds_read_b64_tr_b16 a[224:225], v15 offset:19520
ds_read_b64_tr_b16 a[226:227], v15 offset:20288
ds_read_b32 v174, v196 offset:1920
v_mfma_f32_32x32x16_bf16 v[48:63], a[192:195], a[136:139], v[48:63]
buffer_load_dwordx4 v232, s[32:35], s78 offen offset:1024 sc1 lds
ds_read_b64_tr_b16 a[228:229], v15 offset:19584
ds_read_b64_tr_b16 a[230:231], v15 offset:20352
ds_read_b32 v175, v196 offset:2816
ds_read_b32 v176, v196 offset:256
s_waitcnt lgkmcnt(15)
v_mfma_f32_32x32x16_bf16 v[16:31], a[196:199], a[140:143], v[16:31]
ds_read_b128 a[152:155], v11 offset:0
ds_read_b64_tr_b16 a[232:233], v15 offset:22528
ds_read_b64_tr_b16 a[234:235], v15 offset:23296
ds_read_b32 v177, v196 offset:1152
ds_read_b32 v178, v196 offset:2048
ds_read_b32 v179, v196 offset:2944
v_mfma_f32_32x32x16_bf16 v[32:47], a[200:203], a[140:143], v[32:47]
buffer_load_dwordx4 v232, s[32:35], s78 offen offset:2048 sc1 lds
ds_read_b64_tr_b16 a[236:237], v15 offset:22592
ds_read_b64_tr_b16 a[238:239], v15 offset:23360
s_waitcnt lgkmcnt(15)
v_add_f32 v168, v168, v169
v_add_f32 v170, v170, v171
v_add_f32 v172, v172, v173
v_mfma_f32_32x32x16_bf16 v[48:63], a[204:207], a[140:143], v[48:63]
buffer_load_dwordx4 v232, s[32:35], s78 offen offset:3072 sc1 lds
ds_read_b64_tr_b16 a[240:241], v15 offset:22656
ds_read_b64_tr_b16 a[242:243], v15 offset:23424
s_waitcnt lgkmcnt(11)
v_add_f32 v174, v174, v175
s_waitcnt lgkmcnt(6)
v_add_f32 v176, v176, v177
v_mfma_f32_32x32x16_bf16 v[16:31], a[208:211], a[144:147], v[16:31]
s_add_u32 m0, s65, 32768
s_add_u32 s78, s78, 4096
buffer_load_dwordx4 v232, s[32:35], s78 offen offset:0 sc1 lds
ds_read_b128 a[156:159], v12 offset:0
ds_read_b64_tr_b16 a[244:245], v15 offset:25600
ds_read_b64_tr_b16 a[246:247], v15 offset:26368
v_mfma_f32_32x32x16_bf16 v[32:47], a[212:215], a[144:147], v[32:47]
buffer_load_dwordx4 v232, s[32:35], s78 offen offset:1024 sc1 lds
ds_read_b64_tr_b16 a[248:249], v15 offset:25664
ds_read_b64_tr_b16 a[250:251], v15 offset:26432
s_waitcnt lgkmcnt(9)
v_add_f32 v178, v178, v179
v_add_f32 v170, v168, v170
v_add_f32 v174, v172, v174
v_mfma_f32_32x32x16_bf16 v[48:63], a[216:219], a[144:147], v[48:63]
ds_read_b64_tr_b16 a[252:253], v15 offset:25728
ds_read_b64_tr_b16 a[254:255], v15 offset:26496
v_add_f32 v178, v176, v178
v_mul_f32 v170, v170, v197
v_mul_f32 v174, v174, v197
v_mfma_f32_32x32x16_bf16 v[16:31], a[220:223], a[148:151], v[16:31]
s_add_u32 m0, s65, 57344
s_add_u32 s78, s64, 49152
buffer_load_dwordx4 v232, s[32:35], s78 offen offset:0 sc1 lds
v_mul_f32 v178, v178, v197
v_cvt_pk_bf16_f32 v168, v170, v170
v_cvt_pk_bf16_f32 v172, v174, v174
v_mfma_f32_32x32x16_bf16 v[32:47], a[224:227], a[148:151], v[32:47]
buffer_load_dwordx4 v232, s[32:35], s78 offen offset:1024 sc1 lds
v_cvt_pk_bf16_f32 v176, v178, v178
v_lshlrev_b32 v171, 16, v168
v_lshlrev_b32 v175, 16, v172
v_lshlrev_b32 v179, 16, v176
v_sub_f32 v170, v170, v171
v_mfma_f32_32x32x16_bf16 v[48:63], a[228:231], a[148:151], v[48:63]
buffer_load_dwordx4 v232, s[32:35], s78 offen offset:2048 sc1 lds
v_sub_f32 v174, v174, v175
v_sub_f32 v178, v178, v179
v_cvt_pk_bf16_f32 v169, v170, v216
v_mov_b32 v171, 0
s_waitcnt lgkmcnt(7)
v_mfma_f32_32x32x16_bf16 v[16:31], a[232:235], a[152:155], v[16:31]
v_cvt_pk_bf16_f32 v173, v174, v217
v_mov_b32 v175, 0
v_cvt_pk_bf16_f32 v177, v178, v218
v_mov_b32 v179, 0
v_cvt_pk_bf16_f32 v170, v216, v198
v_cvt_pk_bf16_f32 v174, v217, v198
v_mfma_f32_32x32x16_bf16 v[32:47], a[236:239], a[152:155], v[32:47]
buffer_load_dwordx4 v232, s[32:35], s78 offen offset:3072 sc1 lds
v_cvt_pk_bf16_f32 v178, v218, v198
ds_read_b32 v180, v196 offset:384
ds_read_b32 v181, v196 offset:1280
ds_read_b32 v182, v196 offset:2176
ds_read_b32 v183, v196 offset:3072
v_mfma_f32_32x32x16_bf16 v[48:63], a[240:243], a[152:155], v[48:63]
s_add_u32 m0, s65, 61440
s_add_u32 s78, s78, 4096
buffer_load_dwordx4 v232, s[32:35], s78 offen offset:0 sc1 lds
ds_read_b32 v184, v196 offset:512
ds_read_b32 v185, v196 offset:1408
s_waitcnt lgkmcnt(6)
v_mfma_f32_32x32x16_bf16 v[16:31], a[244:247], a[156:159], v[16:31]
buffer_load_dwordx4 v232, s[32:35], s78 offen offset:1024 sc1 lds
ds_read_b32 v186, v196 offset:2304
ds_read_b32 v187, v196 offset:3200
ds_read_b32 v188, v196 offset:640
ds_read_b32 v189, v196 offset:1536
ds_read_b32 v190, v196 offset:2432
v_mfma_f32_32x32x16_bf16 v[32:47], a[248:251], a[156:159], v[32:47]
ds_read_b32 v191, v196 offset:3328
ds_read_b32 v192, v196 offset:768
ds_read_b32 v193, v196 offset:1664
ds_read_b32 v194, v196 offset:2560
ds_read_b32 v195, v196 offset:3456
s_waitcnt lgkmcnt(14)
v_add_f32 v180, v180, v181
v_mfma_f32_32x32x16_bf16 v[48:63], a[252:255], a[156:159], v[48:63]
s_waitcnt lgkmcnt(12)
v_add_f32 v182, v182, v183
s_waitcnt lgkmcnt(10)
v_add_f32 v184, v184, v185
s_waitcnt lgkmcnt(8)
v_add_f32 v186, v186, v187
s_waitcnt lgkmcnt(6)
v_add_f32 v188, v188, v189
s_waitcnt lgkmcnt(4)
v_add_f32 v190, v190, v191
v_mfma_f32_32x32x16_bf16 v[16:31], v[168:171], v[128:131], v[16:31]
s_waitcnt lgkmcnt(2)
v_add_f32 v192, v192, v193
s_waitcnt lgkmcnt(0)
v_add_f32 v194, v194, v195
v_add_f32 v182, v180, v182
v_add_f32 v186, v184, v186
v_add_f32 v190, v188, v190
v_add_f32 v194, v192, v194
v_mfma_f32_32x32x16_bf16 v[32:47], v[172:175], v[128:131], v[32:47]
v_mul_f32 v182, v182, v197
v_mul_f32 v186, v186, v197
v_mul_f32 v190, v190, v197
v_mul_f32 v194, v194, v197
v_cvt_pk_bf16_f32 v180, v182, v182
v_cvt_pk_bf16_f32 v184, v186, v186
v_mfma_f32_32x32x16_bf16 v[48:63], v[176:179], v[128:131], v[48:63]
v_cvt_pk_bf16_f32 v188, v190, v190
v_cvt_pk_bf16_f32 v192, v194, v194
v_lshlrev_b32 v183, 16, v180
v_lshlrev_b32 v187, 16, v184
v_lshlrev_b32 v191, 16, v188
v_lshlrev_b32 v195, 16, v192
v_sub_f32 v182, v182, v183
v_sub_f32 v186, v186, v187
v_sub_f32 v190, v190, v191
v_sub_f32 v194, v194, v195
v_cvt_pk_bf16_f32 v181, v182, v198
v_mov_b32 v183, 0
v_cvt_pk_bf16_f32 v185, v186, v198
v_mov_b32 v187, 0
v_cvt_pk_bf16_f32 v189, v190, v199
v_mov_b32 v191, 0
v_cvt_pk_bf16_f32 v193, v194, v198
v_mov_b32 v195, 0
v_cvt_pk_bf16_f32 v182, v198, v198
v_cvt_pk_bf16_f32 v186, v198, v198
v_cvt_pk_bf16_f32 v190, v199, v198
v_cvt_pk_bf16_f32 v194, v198, v198
s_waitcnt vmcnt(12)
s_barrier
buffer_load_dword v236, v235, s[32:35], 0 offen sc1
ds_read_b128 a[160:163], v232 offset:0
ds_read_b128 a[164:167], v232 offset:1024
ds_read_b128 a[168:171], v232 offset:2048
ds_read_b128 a[172:175], v232 offset:3072
ds_read_b128 a[176:179], v232 offset:4096
s_waitcnt lgkmcnt(2)
v_mfma_f32_32x32x16_bf16 v[64:79], a[0:3], a[160:163], 0
s_add_u32 m0, s65, 86016
s_add_u32 s78, s64, 73728
buffer_load_dwordx4 v232, s[32:35], s78 offen offset:0 sc1 lds
ds_read_b128 a[180:183], v232 offset:5120
ds_read_b128 a[184:187], v232 offset:6144
v_mul_f32 v196, v16, v133
v_mfma_f32_32x32x16_bf16 v[80:95], a[0:3], a[164:167], 0
buffer_load_dwordx4 v232, s[32:35], s78 offen offset:1024 sc1 lds
ds_read_b128 a[188:191], v232 offset:7168
ds_read_b128 a[192:195], v232 offset:8192
v_mul_f32 v197, v17, v133
v_mul_f32 v198, v18, v133
v_mul_f32 v199, v19, v133
v_mfma_f32_32x32x16_bf16 v[96:111], a[0:3], a[168:171], 0
buffer_load_dwordx4 v232, s[32:35], s78 offen offset:2048 sc1 lds
ds_read_b128 a[196:199], v232 offset:9216
ds_read_b128 a[200:203], v232 offset:10240
v_exp_f32 v196, v196
s_waitcnt lgkmcnt(5)
v_mfma_f32_32x32x16_bf16 v[112:127], a[172:175], a[0:3], 0
buffer_load_dwordx4 v232, s[32:35], s78 offen offset:3072 sc1 lds
ds_read_b128 a[204:207], v232 offset:11264
ds_read_b128 a[208:211], v232 offset:12288
v_exp_f32 v197, v197
v_mfma_f32_32x32x16_bf16 v[64:79], a[4:7], a[176:179], v[64:79]
s_add_u32 m0, s65, 90112
s_add_u32 s78, s78, 4096
buffer_load_dwordx4 v232, s[32:35], s78 offen offset:0 sc1 lds
ds_read_b128 a[212:215], v232 offset:13312
v_exp_f32 v198, v198
v_mfma_f32_32x32x16_bf16 v[80:95], a[4:7], a[180:183], v[80:95]
buffer_load_dwordx4 v232, s[32:35], s78 offen offset:1024 sc1 lds
ds_read_b128 a[216:219], v232 offset:14336
v_exp_f32 v199, v199
v_add_f32 v200, 2.0, v196
s_waitcnt lgkmcnt(6)
v_mfma_f32_32x32x16_bf16 v[96:111], a[4:7], a[184:187], v[96:111]
ds_read_b128 a[220:223], v232 offset:15360
v_add_f32 v201, 2.0, v197
v_add_f32 v202, 2.0, v198
v_add_f32 v203, 2.0, v199
v_fma_f32 v196, v196, v200, 2.0
v_fma_f32 v197, v197, v201, 2.0
v_mfma_f32_32x32x16_bf16 v[112:127], a[188:191], a[4:7], v[112:127]
ds_read_b128 a[224:227], v232 offset:16384
v_fma_f32 v198, v198, v202, 2.0
v_fma_f32 v199, v199, v203, 2.0
v_rcp_f32 v196, v196
v_mfma_f32_32x32x16_bf16 v[64:79], a[8:11], a[192:195], v[64:79]
ds_read_b128 a[228:231], v232 offset:17408
v_rcp_f32 v197, v197
v_rcp_f32 v198, v198
s_waitcnt lgkmcnt(6)
v_mfma_f32_32x32x16_bf16 v[80:95], a[8:11], a[196:199], v[80:95]
ds_read_b128 a[232:235], v232 offset:18432
v_rcp_f32 v199, v199
v_fma_f32 v196, v196, v134, v132
v_fma_f32 v197, v197, v134, v132
v_fma_f32 v198, v198, v134, v132
v_mfma_f32_32x32x16_bf16 v[96:111], a[8:11], a[200:203], v[96:111]
ds_read_b128 a[236:239], v232 offset:19456
v_fma_f32 v199, v199, v134, v132
v_mul_f32 v196, v16, v196
v_mul_f32 v197, v17, v197
v_mul_f32 v198, v18, v198
v_mul_f32 v199, v19, v199
v_mfma_f32_32x32x16_bf16 v[112:127], a[204:207], a[8:11], v[112:127]
ds_read_b128 a[240:243], v232 offset:20480
v_cvt_pk_bf16_f32 v16, v196, v197
v_cvt_pk_bf16_f32 v17, v198, v199
v_mul_f32 v204, v20, v133
v_mul_f32 v205, v21, v133
s_waitcnt lgkmcnt(6)
v_mfma_f32_32x32x16_bf16 v[64:79], a[12:15], a[208:211], v[64:79]
ds_read_b128 a[244:247], v232 offset:21504
v_mul_f32 v206, v22, v133
v_mul_f32 v207, v23, v133
v_exp_f32 v204, v204
v_mfma_f32_32x32x16_bf16 v[80:95], a[12:15], a[212:215], v[80:95]
ds_read_b128 a[248:251], v232 offset:22528
v_exp_f32 v205, v205
v_exp_f32 v206, v206
v_mfma_f32_32x32x16_bf16 v[96:111], a[12:15], a[216:219], v[96:111]
ds_read_b128 a[252:255], v232 offset:23552
v_exp_f32 v207, v207
v_add_f32 v208, 2.0, v204
v_add_f32 v209, 2.0, v205
s_waitcnt lgkmcnt(6)
v_mfma_f32_32x32x16_bf16 v[112:127], a[220:223], a[12:15], v[112:127]
s_waitcnt vmcnt(13)
s_barrier
s_waitcnt vmcnt(6)
v_cmp_ne_u32 s[58:59], 0, v236
s_nop 1
s_cmp_eq_u64 s[58:59], -1
s_cbranch_scc0 L_fb_c
L_ok_c:
v_mfma_f32_32x32x16_bf16 v[64:79], a[16:19], a[224:227], v[64:79]
s_mul_i32 s84, s40, 11264
s_add_u32 m0, s84, 114688
s_add_u32 s85, s80, 40960
buffer_load_dwordx4 v232, s[32:35], s85 offen offset:0 sc1 lds
ds_read_b128 a[160:163], v232 offset:28672
ds_read_b128 a[164:167], v232 offset:29696
v_mfma_f32_32x32x16_bf16 v[80:95], a[16:19], a[228:231], v[80:95]
buffer_load_dwordx4 v232, s[32:35], s85 offen offset:1024 sc1 lds
ds_read_b128 a[168:171], v232 offset:30720
v_add_f32 v210, 2.0, v206
v_add_f32 v211, 2.0, v207
v_fma_f32 v204, v204, v208, 2.0
s_waitcnt lgkmcnt(6)
v_mfma_f32_32x32x16_bf16 v[96:111], a[16:19], a[232:235], v[96:111]
buffer_load_dwordx4 v232, s[32:35], s85 offen offset:2048 sc1 lds
ds_read_b128 a[172:175], v232 offset:31744
v_fma_f32 v205, v205, v209, 2.0
v_fma_f32 v206, v206, v210, 2.0
v_fma_f32 v207, v207, v211, 2.0
v_mfma_f32_32x32x16_bf16 v[112:127], a[236:239], a[16:19], v[112:127]
buffer_load_dwordx4 v232, s[32:35], s85 offen offset:3072 sc1 lds
ds_read_b128 a[176:179], v232 offset:32768
v_rcp_f32 v204, v204
v_rcp_f32 v205, v205
v_mfma_f32_32x32x16_bf16 v[64:79], a[20:23], a[240:243], v[64:79]
s_mul_i32 s84, s40, 11264
s_add_u32 m0, s84, 118784
s_add_u32 s85, s80, 45056
buffer_load_dwordx4 v232, s[32:35], s85 offen offset:0 sc1 lds
ds_read_b128 a[180:183], v232 offset:33792
s_waitcnt lgkmcnt(6)
v_mfma_f32_32x32x16_bf16 v[80:95], a[20:23], a[244:247], v[80:95]
s_mul_i32 s84, s40, 11264
s_add_u32 m0, s84, 119808
s_add_u32 s85, s80, 46080
buffer_load_dwordx4 v232, s[32:35], s85 offen offset:0 sc1 lds
ds_read_b128 a[184:187], v232 offset:34816
v_mfma_f32_32x32x16_bf16 v[96:111], a[20:23], a[248:251], v[96:111]
ds_read_b128 a[188:191], v232 offset:35840
v_rcp_f32 v206, v206
v_rcp_f32 v207, v207
v_fma_f32 v204, v204, v134, v132
v_mfma_f32_32x32x16_bf16 v[112:127], a[252:255], a[20:23], v[112:127]
buffer_load_dwordx4 v232, s[32:35], s85 offen offset:1024 sc1 lds
ds_read_b128 a[192:195], v232 offset:36864
v_fma_f32 v205, v205, v134, v132
v_fma_f32 v206, v206, v134, v132
v_fma_f32 v207, v207, v134, v132
s_waitcnt lgkmcnt(6)
v_mfma_f32_32x32x16_bf16 v[64:79], a[24:27], a[160:163], v[64:79]
buffer_load_dwordx4 v232, s[32:35], s85 offen offset:2048 sc1 lds
ds_read_b128 a[196:199], v232 offset:37888
v_mul_f32 v204, v20, v204
v_mul_f32 v205, v21, v205
v_mul_f32 v206, v22, v206
v_mul_f32 v207, v23, v207
v_mfma_f32_32x32x16_bf16 v[80:95], a[24:27], a[164:167], v[80:95]
ds_read_b128 a[200:203], v232 offset:38912
v_cvt_pk_bf16_f32 v18, v204, v205
v_cvt_pk_bf16_f32 v19, v206, v207
v_mul_f32 v196, v24, v133
v_mul_f32 v197, v25, v133
v_mul_f32 v198, v26, v133
v_mfma_f32_32x32x16_bf16 v[96:111], a[24:27], a[168:171], v[96:111]
buffer_load_dwordx4 v232, s[32:35], s85 offen offset:3072 sc1 lds
ds_read_b128 a[204:207], v232 offset:39936
v_mul_f32 v199, v27, v133
v_exp_f32 v196, v196
s_waitcnt lgkmcnt(6)
v_mfma_f32_32x32x16_bf16 v[112:127], a[172:175], a[24:27], v[112:127]
s_mul_i32 s84, s40, 11264
s_add_u32 m0, s84, 123904
s_add_u32 s85, s80, 50176
buffer_load_dwordx4 v232, s[32:35], s85 offen offset:0 sc1 lds
ds_read_b128 a[208:211], v232 offset:40960
v_mfma_f32_32x32x16_bf16 v[64:79], a[28:31], a[176:179], v[64:79]
buffer_load_dwordx4 v232, s[32:35], s85 offen offset:1024 sc1 lds
ds_read_b128 a[212:215], v232 offset:41984
v_exp_f32 v197, v197
v_exp_f32 v198, v198
v_mfma_f32_32x32x16_bf16 v[80:95], a[28:31], a[180:183], v[80:95]
ds_read_b128 a[216:219], v232 offset:43008
v_exp_f32 v199, v199
v_add_f32 v200, 2.0, v196
v_add_f32 v201, 2.0, v197
s_waitcnt lgkmcnt(6)
v_mfma_f32_32x32x16_bf16 v[96:111], a[28:31], a[184:187], v[96:111]
s_mul_i32 s84, s40, 1024
s_add_u32 m0, s84, 53248
s_add_u32 s85, s80, 52224
buffer_load_dwordx4 v232, s[32:35], s85 offen offset:0 sc1 lds
ds_read_b128 a[220:223], v232 offset:44032
v_add_f32 v202, 2.0, v198
v_mfma_f32_32x32x16_bf16 v[112:127], a[188:191], a[28:31], v[112:127]
s_mul_i32 s84, s40, 1024
s_add_u32 m0, s84, 81920
s_add_u32 s85, s80, 53248
buffer_load_dwordx4 v232, s[32:35], s85 offen offset:0 sc1 lds
ds_read_b128 a[224:227], v232 offset:45056
v_add_f32 v203, 2.0, v199
v_mfma_f32_32x32x16_bf16 v[64:79], a[32:35], a[192:195], v[64:79]
ds_read_b128 a[228:231], v232 offset:46080
v_fma_f32 v196, v196, v200, 2.0
v_fma_f32 v197, v197, v201, 2.0
v_fma_f32 v198, v198, v202, 2.0
v_fma_f32 v199, v199, v203, 2.0
s_waitcnt lgkmcnt(6)
v_mfma_f32_32x32x16_bf16 v[80:95], a[32:35], a[196:199], v[80:95]
s_mul_i32 s84, s40, 1024
s_add_u32 m0, s84, 110592
s_add_u32 s85, s80, 54272
buffer_load_dwordx4 v232, s[32:35], s85 offen offset:0 sc1 lds
ds_read_b128 a[232:235], v232 offset:47104
v_mfma_f32_32x32x16_bf16 v[96:111], a[32:35], a[200:203], v[96:111]
s_add_u32 s84, s80, 0
buffer_load_dwordx4 a[0:3], v232, s[32:35], s84 offen offset:0 sc1
ds_read_b128 a[236:239], v232 offset:48128
v_rcp_f32 v196, v196
v_mfma_f32_32x32x16_bf16 v[112:127], a[204:207], a[32:35], v[112:127]
buffer_load_dwordx4 a[4:7], v232, s[32:35], s84 offen offset:1024 sc1
ds_read_b128 a[240:243], v232 offset:49152
v_rcp_f32 v197, v197
s_waitcnt lgkmcnt(6)
v_mfma_f32_32x32x16_bf16 v[64:79], a[36:39], a[208:211], v[64:79]
ds_read_b128 a[244:247], v232 offset:50176
v_rcp_f32 v198, v198
v_rcp_f32 v199, v199
v_fma_f32 v196, v196, v134, v132
v_mfma_f32_32x32x16_bf16 v[80:95], a[36:39], a[212:215], v[80:95]
buffer_load_dwordx4 a[8:11], v232, s[32:35], s84 offen offset:2048 sc1
ds_read_b128 a[248:251], v232 offset:51200
v_fma_f32 v197, v197, v134, v132
v_fma_f32 v198, v198, v134, v132
v_fma_f32 v199, v199, v134, v132
v_mul_f32 v196, v24, v196
v_mfma_f32_32x32x16_bf16 v[96:111], a[36:39], a[216:219], v[96:111]
buffer_load_dwordx4 a[12:15], v232, s[32:35], s84 offen offset:3072 sc1
ds_read_b128 a[252:255], v232 offset:52224
v_mul_f32 v197, v25, v197
v_mul_f32 v198, v26, v198
v_mul_f32 v199, v27, v199
s_waitcnt lgkmcnt(6)
v_mfma_f32_32x32x16_bf16 v[112:127], a[220:223], a[36:39], v[112:127]
s_barrier
buffer_load_dwordx4 a[16:19], v249, s[32:35], s84 offen offset:0 sc1
ds_read_b128 a[160:163], v233 offset:0
v_cvt_pk_bf16_f32 v24, v196, v197
v_cvt_pk_bf16_f32 v25, v198, v199
v_mfma_f32_32x32x16_bf16 v[64:79], a[40:43], a[224:227], v[64:79]
ds_read_b128 a[164:167], v233 offset:1024
v_mul_f32 v204, v28, v133
v_mul_f32 v205, v29, v133
v_mul_f32 v206, v30, v133
v_mul_f32 v207, v31, v133
v_mfma_f32_32x32x16_bf16 v[80:95], a[40:43], a[228:231], v[80:95]
s_add_u32 m0, s65, 0
s_add_u32 s78, s64, 98304
buffer_load_dwordx4 v232, s[32:35], s78 offen offset:0 sc1 lds
ds_read_b128 a[168:171], v233 offset:2048
s_waitcnt lgkmcnt(6)
v_mfma_f32_32x32x16_bf16 v[96:111], a[40:43], a[232:235], v[96:111]
buffer_load_dwordx4 v232, s[32:35], s78 offen offset:1024 sc1 lds
ds_read_b128 a[172:175], v233 offset:3072
v_exp_f32 v204, v204
v_exp_f32 v205, v205
v_mfma_f32_32x32x16_bf16 v[112:127], a[236:239], a[40:43], v[112:127]
ds_read_b128 a[176:179], v233 offset:4096
v_exp_f32 v206, v206
v_exp_f32 v207, v207
v_add_f32 v208, 2.0, v204
v_mfma_f32_32x32x16_bf16 v[64:79], a[44:47], a[240:243], v[64:79]
buffer_load_dwordx4 v232, s[32:35], s78 offen offset:2048 sc1 lds
ds_read_b128 a[180:183], v233 offset:5120
v_add_f32 v209, 2.0, v205
v_add_f32 v210, 2.0, v206
v_add_f32 v211, 2.0, v207
s_waitcnt lgkmcnt(6)
v_mfma_f32_32x32x16_bf16 v[80:95], a[44:47], a[244:247], v[80:95]
buffer_load_dwordx4 v232, s[32:35], s78 offen offset:3072 sc1 lds
ds_read_b128 a[184:187], v233 offset:6144
v_fma_f32 v204, v204, v208, 2.0
v_fma_f32 v205, v205, v209, 2.0
v_fma_f32 v206, v206, v210, 2.0
v_fma_f32 v207, v207, v211, 2.0
v_mfma_f32_32x32x16_bf16 v[96:111], a[44:47], a[248:251], v[96:111]
s_add_u32 m0, s65, 4096
s_add_u32 s78, s78, 4096
buffer_load_dwordx4 v232, s[32:35], s78 offen offset:0 sc1 lds
ds_read_b128 a[188:191], v233 offset:7168
v_rcp_f32 v204, v204
v_mfma_f32_32x32x16_bf16 v[112:127], a[252:255], a[44:47], v[112:127]
ds_read_b128 a[192:195], v233 offset:8192
v_rcp_f32 v205, v205
v_rcp_f32 v206, v206
s_waitcnt lgkmcnt(6)
v_mfma_f32_32x32x16_bf16 v[64:79], a[48:51], a[160:163], v[64:79]
buffer_load_dwordx4 v232, s[32:35], s78 offen offset:1024 sc1 lds
ds_read_b128 a[196:199], v233 offset:9216
v_rcp_f32 v207, v207
v_fma_f32 v204, v204, v134, v132
v_fma_f32 v205, v205, v134, v132
v_mfma_f32_32x32x16_bf16 v[80:95], a[48:51], a[164:167], v[80:95]
s_add_u32 s84, s80, 5120
buffer_load_dwordx4 a[20:23], v232, s[32:35], s84 offen offset:0 sc1
ds_read_b128 a[200:203], v233 offset:10240
v_fma_f32 v206, v206, v134, v132
v_fma_f32 v207, v207, v134, v132
v_mul_f32 v204, v28, v204
v_mfma_f32_32x32x16_bf16 v[96:111], a[48:51], a[168:171], v[96:111]
ds_read_b128 a[204:207], v233 offset:11264
v_mul_f32 v205, v29, v205
v_mul_f32 v206, v30, v206
v_mul_f32 v207, v31, v207
v_cvt_pk_bf16_f32 v26, v204, v205
s_waitcnt lgkmcnt(6)
v_mfma_f32_32x32x16_bf16 v[112:127], a[172:175], a[48:51], v[112:127]
buffer_load_dwordx4 a[24:27], v232, s[32:35], s84 offen offset:1024 sc1
ds_read_b128 a[208:211], v233 offset:12288
v_cvt_pk_bf16_f32 v27, v206, v207
v_mul_f32 v196, v32, v133
v_mul_f32 v197, v33, v133
v_mul_f32 v198, v34, v133
v_mfma_f32_32x32x16_bf16 v[64:79], a[52:55], a[176:179], v[64:79]
buffer_load_dwordx4 a[28:31], v232, s[32:35], s84 offen offset:2048 sc1
ds_read_b128 a[212:215], v233 offset:13312
v_mul_f32 v199, v35, v133
v_exp_f32 v196, v196
v_mfma_f32_32x32x16_bf16 v[80:95], a[52:55], a[180:183], v[80:95]
buffer_load_dwordx4 a[32:35], v232, s[32:35], s84 offen offset:3072 sc1
ds_read_b128 a[216:219], v233 offset:14336
v_exp_f32 v197, v197
s_waitcnt lgkmcnt(6)
v_mfma_f32_32x32x16_bf16 v[96:111], a[52:55], a[184:187], v[96:111]
ds_read_b128 a[220:223], v233 offset:15360
v_exp_f32 v198, v198
v_exp_f32 v199, v199
v_add_f32 v200, 2.0, v196
v_mfma_f32_32x32x16_bf16 v[112:127], a[188:191], a[52:55], v[112:127]
buffer_load_dwordx4 a[36:39], v249, s[32:35], s84 offen offset:0 sc1
ds_read_b128 a[224:227], v233 offset:16384
v_add_f32 v201, 2.0, v197
v_add_f32 v202, 2.0, v198
v_add_f32 v203, 2.0, v199
v_fma_f32 v196, v196, v200, 2.0
v_mfma_f32_32x32x16_bf16 v[64:79], a[56:59], a[192:195], v[64:79]
ds_read_b128 a[228:231], v233 offset:17408
v_fma_f32 v197, v197, v201, 2.0
v_fma_f32 v198, v198, v202, 2.0
v_fma_f32 v199, v199, v203, 2.0
s_waitcnt lgkmcnt(6)
v_mfma_f32_32x32x16_bf16 v[80:95], a[56:59], a[196:199], v[80:95]
ds_read_b128 a[232:235], v233 offset:18432
v_rcp_f32 v196, v196
v_rcp_f32 v197, v197
v_mfma_f32_32x32x16_bf16 v[96:111], a[56:59], a[200:203], v[96:111]
ds_read_b128 a[236:239], v233 offset:19456
v_rcp_f32 v198, v198
v_rcp_f32 v199, v199
v_fma_f32 v196, v196, v134, v132
v_mfma_f32_32x32x16_bf16 v[112:127], a[204:207], a[56:59], v[112:127]
ds_read_b128 a[240:243], v233 offset:20480
v_fma_f32 v197, v197, v134, v132
v_fma_f32 v198, v198, v134, v132
v_fma_f32 v199, v199, v134, v132
v_mul_f32 v196, v32, v196
s_waitcnt lgkmcnt(6)
v_mfma_f32_32x32x16_bf16 v[64:79], a[60:63], a[208:211], v[64:79]
ds_read_b128 a[244:247], v233 offset:21504
v_mul_f32 v197, v33, v197
v_mul_f32 v198, v34, v198
v_mul_f32 v199, v35, v199
v_cvt_pk_bf16_f32 v32, v196, v197
v_cvt_pk_bf16_f32 v33, v198, v199
v_mfma_f32_32x32x16_bf16 v[80:95], a[60:63], a[212:215], v[80:95]
s_add_u32 s84, s80, 10240
buffer_load_dwordx4 a[40:43], v232, s[32:35], s84 offen offset:0 sc1
ds_read_b128 a[248:251], v233 offset:22528
v_mul_f32 v204, v36, v133
v_mul_f32 v205, v37, v133
v_mul_f32 v206, v38, v133
v_mfma_f32_32x32x16_bf16 v[96:111], a[60:63], a[216:219], v[96:111]
buffer_load_dwordx4 a[44:47], v232, s[32:35], s84 offen offset:1024 sc1
ds_read_b128 a[252:255], v233 offset:23552
v_mul_f32 v207, v39, v133
v_exp_f32 v204, v204
s_waitcnt lgkmcnt(6)
v_mfma_f32_32x32x16_bf16 v[112:127], a[220:223], a[60:63], v[112:127]
s_waitcnt vmcnt(32)
s_barrier
buffer_load_dwordx4 a[48:51], v232, s[32:35], s84 offen offset:2048 sc1
ds_read_b128 a[160:163], v233 offset:28672
v_exp_f32 v205, v205
v_mfma_f32_32x32x16_bf16 v[64:79], a[64:67], a[224:227], v[64:79]
buffer_load_dwordx4 a[52:55], v232, s[32:35], s84 offen offset:3072 sc1
ds_read_b128 a[164:167], v233 offset:29696
v_exp_f32 v206, v206
v_exp_f32 v207, v207
v_mfma_f32_32x32x16_bf16 v[80:95], a[64:67], a[228:231], v[80:95]
buffer_load_dwordx4 a[56:59], v249, s[32:35], s84 offen offset:0 sc1
ds_read_b128 a[168:171], v233 offset:30720
v_add_f32 v208, 2.0, v204
v_add_f32 v209, 2.0, v205
v_add_f32 v210, 2.0, v206
s_waitcnt lgkmcnt(6)
v_mfma_f32_32x32x16_bf16 v[96:111], a[64:67], a[232:235], v[96:111]
s_add_u32 m0, s65, 28672
s_add_u32 s78, s64, 122880
buffer_load_dwordx4 v232, s[32:35], s78 offen offset:0 sc1 lds
ds_read_b128 a[172:175], v233 offset:31744
v_add_f32 v211, 2.0, v207
v_fma_f32 v204, v204, v208, 2.0
v_mfma_f32_32x32x16_bf16 v[112:127], a[236:239], a[64:67], v[112:127]
ds_read_b128 a[176:179], v233 offset:32768
v_fma_f32 v205, v205, v209, 2.0
v_fma_f32 v206, v206, v210, 2.0
v_fma_f32 v207, v207, v211, 2.0
v_rcp_f32 v204, v204
v_mfma_f32_32x32x16_bf16 v[64:79], a[68:71], a[240:243], v[64:79]
buffer_load_dwordx4 v232, s[32:35], s78 offen offset:1024 sc1 lds
ds_read_b128 a[180:183], v233 offset:33792
v_rcp_f32 v205, v205
s_waitcnt lgkmcnt(6)
v_mfma_f32_32x32x16_bf16 v[80:95], a[68:71], a[244:247], v[80:95]
buffer_load_dwordx4 v232, s[32:35], s78 offen offset:2048 sc1 lds
ds_read_b128 a[184:187], v233 offset:34816
v_rcp_f32 v206, v206
v_rcp_f32 v207, v207
v_mfma_f32_32x32x16_bf16 v[96:111], a[68:71], a[248:251], v[96:111]
ds_read_b128 a[188:191], v233 offset:35840
v_fma_f32 v204, v204, v134, v132
v_fma_f32 v205, v205, v134, v132
v_fma_f32 v206, v206, v134, v132
v_fma_f32 v207, v207, v134, v132
v_mul_f32 v204, v36, v204
v_mfma_f32_32x32x16_bf16 v[112:127], a[252:255], a[68:71], v[112:127]
buffer_load_dwordx4 v232, s[32:35], s78 offen offset:3072 sc1 lds
ds_read_b128 a[192:195], v233 offset:36864
v_mul_f32 v205, v37, v205
v_mul_f32 v206, v38, v206
v_mul_f32 v207, v39, v207
s_waitcnt lgkmcnt(6)
v_mfma_f32_32x32x16_bf16 v[64:79], a[72:75], a[160:163], v[64:79]
s_add_u32 m0, s65, 32768
s_add_u32 s78, s78, 4096
buffer_load_dwordx4 v232, s[32:35], s78 offen offset:0 sc1 lds
ds_read_b128 a[196:199], v233 offset:37888
v_cvt_pk_bf16_f32 v34, v204, v205
v_cvt_pk_bf16_f32 v35, v206, v207
v_mfma_f32_32x32x16_bf16 v[80:95], a[72:75], a[164:167], v[80:95]
buffer_load_dwordx4 v232, s[32:35], s78 offen offset:1024 sc1 lds
ds_read_b128 a[200:203], v233 offset:38912
v_mul_f32 v196, v40, v133
v_mul_f32 v197, v41, v133
v_mul_f32 v198, v42, v133
v_mul_f32 v199, v43, v133
v_mfma_f32_32x32x16_bf16 v[96:111], a[72:75], a[168:171], v[96:111]
ds_read_b128 a[204:207], v233 offset:39936
v_exp_f32 v196, v196
v_exp_f32 v197, v197
s_waitcnt lgkmcnt(6)
v_mfma_f32_32x32x16_bf16 v[112:127], a[172:175], a[72:75], v[112:127]
ds_read_b128 a[208:211], v233 offset:40960
v_exp_f32 v198, v198
v_exp_f32 v199, v199
v_add_f32 v200, 2.0, v196
v_mfma_f32_32x32x16_bf16 v[64:79], a[76:79], a[176:179], v[64:79]
ds_read_b128 a[212:215], v233 offset:41984
v_add_f32 v201, 2.0, v197
v_add_f32 v202, 2.0, v198
v_add_f32 v203, 2.0, v199
v_fma_f32 v196, v196, v200, 2.0
v_fma_f32 v197, v197, v201, 2.0
v_mfma_f32_32x32x16_bf16 v[80:95], a[76:79], a[180:183], v[80:95]
ds_read_b128 a[216:219], v233 offset:43008
v_fma_f32 v198, v198, v202, 2.0
v_fma_f32 v199, v199, v203, 2.0
v_rcp_f32 v196, v196
s_waitcnt lgkmcnt(6)
v_mfma_f32_32x32x16_bf16 v[96:111], a[76:79], a[184:187], v[96:111]
ds_read_b128 a[220:223], v233 offset:44032
v_rcp_f32 v197, v197
v_rcp_f32 v198, v198
v_mfma_f32_32x32x16_bf16 v[112:127], a[188:191], a[76:79], v[112:127]
ds_read_b128 a[224:227], v233 offset:45056
v_rcp_f32 v199, v199
v_fma_f32 v196, v196, v134, v132
v_fma_f32 v197, v197, v134, v132
v_fma_f32 v198, v198, v134, v132
v_mfma_f32_32x32x16_bf16 v[64:79], a[80:83], a[192:195], v[64:79]
ds_read_b128 a[228:231], v233 offset:46080
v_fma_f32 v199, v199, v134, v132
v_mul_f32 v196, v40, v196
v_mul_f32 v197, v41, v197
v_mul_f32 v198, v42, v198
s_waitcnt lgkmcnt(6)
v_mfma_f32_32x32x16_bf16 v[80:95], a[80:83], a[196:199], v[80:95]
s_add_u32 s84, s80, 15360
buffer_load_dwordx4 a[60:63], v232, s[32:35], s84 offen offset:0 sc1
ds_read_b128 a[232:235], v233 offset:47104
v_mul_f32 v199, v43, v199
v_cvt_pk_bf16_f32 v40, v196, v197
v_cvt_pk_bf16_f32 v41, v198, v199
v_mfma_f32_32x32x16_bf16 v[96:111], a[80:83], a[200:203], v[96:111]
buffer_load_dwordx4 a[64:67], v232, s[32:35], s84 offen offset:1024 sc1
ds_read_b128 a[236:239], v233 offset:48128
v_mul_f32 v204, v44, v133
v_mul_f32 v205, v45, v133
v_mul_f32 v206, v46, v133
v_mul_f32 v207, v47, v133
v_mfma_f32_32x32x16_bf16 v[112:127], a[204:207], a[80:83], v[112:127]
buffer_load_dwordx4 a[68:71], v232, s[32:35], s84 offen offset:2048 sc1
ds_read_b128 a[240:243], v233 offset:49152
v_exp_f32 v204, v204
s_waitcnt lgkmcnt(6)
v_mfma_f32_32x32x16_bf16 v[64:79], a[84:87], a[208:211], v[64:79]
buffer_load_dwordx4 a[72:75], v232, s[32:35], s84 offen offset:3072 sc1
ds_read_b128 a[244:247], v233 offset:50176
v_exp_f32 v205, v205
v_exp_f32 v206, v206
v_mfma_f32_32x32x16_bf16 v[80:95], a[84:87], a[212:215], v[80:95]
buffer_load_dwordx4 a[76:79], v249, s[32:35], s84 offen offset:0 sc1
ds_read_b128 a[248:251], v233 offset:51200
v_exp_f32 v207, v207
v_add_f32 v208, 2.0, v204
v_add_f32 v209, 2.0, v205
v_mfma_f32_32x32x16_bf16 v[96:111], a[84:87], a[216:219], v[96:111]
ds_read_b128 a[252:255], v233 offset:52224
v_add_f32 v210, 2.0, v206
v_add_f32 v211, 2.0, v207
v_fma_f32 v204, v204, v208, 2.0
v_fma_f32 v205, v205, v209, 2.0
s_waitcnt lgkmcnt(6)
v_mfma_f32_32x32x16_bf16 v[112:127], a[220:223], a[84:87], v[112:127]
s_waitcnt vmcnt(21)
s_barrier
s_add_u32 m0, s61, 57344
s_nop 0
buffer_load_dwordx4 v232, s[32:35], s66 offen offset:0 sc1 lds
ds_read_b128 a[160:163], v232 offset:0
v_mfma_f32_32x32x16_bf16 v[64:79], a[88:91], a[224:227], v[64:79]
buffer_load_dwordx4 v232, s[32:35], s66 offen offset:1024 sc1 lds
ds_read_b128 a[164:167], v232 offset:1024
v_fma_f32 v206, v206, v210, 2.0
v_fma_f32 v207, v207, v211, 2.0
v_rcp_f32 v204, v204
v_mfma_f32_32x32x16_bf16 v[80:95], a[88:91], a[228:231], v[80:95]
buffer_load_dwordx4 v232, s[32:35], s66 offen offset:2048 sc1 lds
ds_read_b128 a[168:171], v232 offset:2048
v_rcp_f32 v205, v205
s_waitcnt lgkmcnt(6)
v_mfma_f32_32x32x16_bf16 v[96:111], a[88:91], a[232:235], v[96:111]
ds_read_b128 a[172:175], v232 offset:4096
v_rcp_f32 v206, v206
v_rcp_f32 v207, v207
v_fma_f32 v204, v204, v134, v132
v_mfma_f32_32x32x16_bf16 v[112:127], a[236:239], a[88:91], v[112:127]
buffer_load_dwordx4 v232, s[32:35], s66 offen offset:3072 sc1 lds
ds_read_b128 a[176:179], v232 offset:5120
v_fma_f32 v205, v205, v134, v132
v_fma_f32 v206, v206, v134, v132
v_fma_f32 v207, v207, v134, v132
v_mul_f32 v204, v44, v204
v_mfma_f32_32x32x16_bf16 v[64:79], a[92:95], a[240:243], v[64:79]
buffer_store_dwordx4 v[16:19], v240, s[32:35], s68 offen offset:0 sc1
ds_read_b128 a[180:183], v232 offset:6144
v_mul_f32 v205, v45, v205
v_mul_f32 v206, v46, v206
v_mul_f32 v207, v47, v207
s_waitcnt lgkmcnt(6)
v_mfma_f32_32x32x16_bf16 v[80:95], a[92:95], a[244:247], v[80:95]
ds_read_b128 a[184:187], v232 offset:8192
v_cvt_pk_bf16_f32 v42, v204, v205
v_cvt_pk_bf16_f32 v43, v206, v207
v_mul_f32 v196, v48, v133
v_mul_f32 v197, v49, v133
v_mul_f32 v198, v50, v133
v_mfma_f32_32x32x16_bf16 v[96:111], a[92:95], a[248:251], v[96:111]
ds_read_b128 a[188:191], v232 offset:9216
v_mul_f32 v199, v51, v133
v_exp_f32 v196, v196
v_exp_f32 v197, v197
v_mfma_f32_32x32x16_bf16 v[112:127], a[252:255], a[92:95], v[112:127]
ds_read_b128 a[192:195], v232 offset:10240
v_exp_f32 v198, v198
v_exp_f32 v199, v199
s_waitcnt lgkmcnt(6)
v_mfma_f32_32x32x16_bf16 v[64:79], a[96:99], a[160:163], v[64:79]
buffer_store_dwordx4 v[24:27], v240, s[32:35], s68 offen offset:512 sc1
ds_read_b128 a[196:199], v232 offset:12288
v_add_f32 v200, 2.0, v196
v_add_f32 v201, 2.0, v197
v_add_f32 v202, 2.0, v198
v_add_f32 v203, 2.0, v199
v_mfma_f32_32x32x16_bf16 v[80:95], a[96:99], a[164:167], v[80:95]
ds_read_b128 a[200:203], v232 offset:13312
v_fma_f32 v196, v196, v200, 2.0
v_fma_f32 v197, v197, v201, 2.0
v_fma_f32 v198, v198, v202, 2.0
v_fma_f32 v199, v199, v203, 2.0
v_mfma_f32_32x32x16_bf16 v[96:111], a[96:99], a[168:171], v[96:111]
ds_read_b128 a[204:207], v232 offset:14336
v_rcp_f32 v196, v196
v_rcp_f32 v197, v197
s_waitcnt lgkmcnt(6)
v_mfma_f32_32x32x16_bf16 v[64:79], a[100:103], a[172:175], v[64:79]
ds_read_b128 a[208:211], v232 offset:16384
v_rcp_f32 v198, v198
v_rcp_f32 v199, v199
v_fma_f32 v196, v196, v134, v132
v_mfma_f32_32x32x16_bf16 v[80:95], a[100:103], a[176:179], v[80:95]
buffer_store_dwordx4 v[32:35], v240, s[32:35], s68 offen offset:1024 sc1
ds_read_b128 a[212:215], v232 offset:17408
v_fma_f32 v197, v197, v134, v132
v_fma_f32 v198, v198, v134, v132
v_fma_f32 v199, v199, v134, v132
v_mul_f32 v196, v48, v196
v_mfma_f32_32x32x16_bf16 v[96:111], a[100:103], a[180:183], v[96:111]
ds_read_b128 a[216:219], v232 offset:18432
v_mul_f32 v197, v49, v197
v_mul_f32 v198, v50, v198
v_mul_f32 v199, v51, v199
v_cvt_pk_bf16_f32 v48, v196, v197
s_waitcnt lgkmcnt(6)
v_mfma_f32_32x32x16_bf16 v[64:79], a[104:107], a[184:187], v[64:79]
ds_read_b128 a[220:223], v232 offset:20480
v_cvt_pk_bf16_f32 v49, v198, v199
v_mul_f32 v204, v52, v133
v_mul_f32 v205, v53, v133
v_mul_f32 v206, v54, v133
v_mul_f32 v207, v55, v133
v_mfma_f32_32x32x16_bf16 v[80:95], a[104:107], a[188:191], v[80:95]
ds_read_b128 a[224:227], v232 offset:21504
v_exp_f32 v204, v204
v_exp_f32 v205, v205
v_mfma_f32_32x32x16_bf16 v[96:111], a[104:107], a[192:195], v[96:111]
buffer_store_dwordx4 v[40:43], v240, s[32:35], s68 offen offset:1536 sc1
ds_read_b128 a[228:231], v232 offset:22528
v_exp_f32 v206, v206
s_waitcnt lgkmcnt(6)
v_mfma_f32_32x32x16_bf16 v[64:79], a[108:111], a[196:199], v[64:79]
s_waitcnt vmcnt(13)
s_barrier
ds_read_b128 a[232:235], v232 offset:28672
v_exp_f32 v207, v207
v_add_f32 v208, 2.0, v204
v_mfma_f32_32x32x16_bf16 v[80:95], a[108:111], a[200:203], v[80:95]
ds_read_b128 a[236:239], v232 offset:29696
v_add_f32 v209, 2.0, v205
v_add_f32 v210, 2.0, v206
v_add_f32 v211, 2.0, v207
v_fma_f32 v204, v204, v208, 2.0
v_fma_f32 v205, v205, v209, 2.0
v_mfma_f32_32x32x16_bf16 v[96:111], a[108:111], a[204:207], v[96:111]
s_mul_i32 s84, s40, 1024
s_add_u32 m0, s84, 73728
s_add_u32 s85, s80, 55296
buffer_load_dwordx4 v232, s[32:35], s85 offen offset:0 sc1 lds
ds_read_b128 a[240:243], v232 offset:30720
s_waitcnt lgkmcnt(6)
v_mfma_f32_32x32x16_bf16 v[64:79], a[112:115], a[208:211], v[64:79]
ds_read_b128 a[244:247], v232 offset:32768
v_fma_f32 v206, v206, v210, 2.0
v_fma_f32 v207, v207, v211, 2.0
v_rcp_f32 v204, v204
v_mfma_f32_32x32x16_bf16 v[80:95], a[112:115], a[212:215], v[80:95]
ds_read_b128 a[248:251], v232 offset:33792
v_rcp_f32 v205, v205
v_rcp_f32 v206, v206
v_mfma_f32_32x32x16_bf16 v[96:111], a[112:115], a[216:219], v[96:111]
ds_read_b128 a[252:255], v232 offset:34816
v_rcp_f32 v207, v207
v_fma_f32 v204, v204, v134, v132
v_fma_f32 v205, v205, v134, v132
s_waitcnt lgkmcnt(6)
v_mfma_f32_32x32x16_bf16 v[64:79], a[116:119], a[220:223], v[64:79]
ds_read_b128 a[160:163], v232 offset:36864
v_fma_f32 v206, v206, v134, v132
v_fma_f32 v207, v207, v134, v132
v_mul_f32 v204, v52, v204
v_mul_f32 v205, v53, v205
v_mul_f32 v206, v54, v206
v_mfma_f32_32x32x16_bf16 v[80:95], a[116:119], a[224:227], v[80:95]
ds_read_b128 a[164:167], v232 offset:37888
v_mul_f32 v207, v55, v207
v_cvt_pk_bf16_f32 v50, v204, v205
v_cvt_pk_bf16_f32 v51, v206, v207
v_mul_f32 v196, v56, v133
v_mul_f32 v197, v57, v133
v_mfma_f32_32x32x16_bf16 v[96:111], a[116:119], a[228:231], v[96:111]
buffer_store_dwordx4 v[48:51], v240, s[32:35], s68 offen offset:2048 sc1
ds_read_b128 a[168:171], v232 offset:38912
v_mul_f32 v198, v58, v133
v_mul_f32 v199, v59, v133
s_waitcnt lgkmcnt(6)
v_mfma_f32_32x32x16_bf16 v[64:79], a[120:123], a[232:235], v[64:79]
ds_read_b128 a[172:175], v232 offset:40960
v_exp_f32 v196, v196
v_exp_f32 v197, v197
v_mfma_f32_32x32x16_bf16 v[80:95], a[120:123], a[236:239], v[80:95]
ds_read_b128 a[176:179], v232 offset:41984
v_exp_f32 v198, v198
v_exp_f32 v199, v199
v_add_f32 v200, 2.0, v196
v_mfma_f32_32x32x16_bf16 v[96:111], a[120:123], a[240:243], v[96:111]
ds_read_b128 a[180:183], v232 offset:43008
v_add_f32 v201, 2.0, v197
v_add_f32 v202, 2.0, v198
v_add_f32 v203, 2.0, v199
v_fma_f32 v196, v196, v200, 2.0
s_waitcnt lgkmcnt(6)
v_mfma_f32_32x32x16_bf16 v[64:79], a[124:127], a[244:247], v[64:79]
ds_read_b128 a[184:187], v232 offset:45056
v_fma_f32 v197, v197, v201, 2.0
v_fma_f32 v198, v198, v202, 2.0
v_fma_f32 v199, v199, v203, 2.0
v_rcp_f32 v196, v196
v_mfma_f32_32x32x16_bf16 v[80:95], a[124:127], a[248:251], v[80:95]
ds_read_b128 a[188:191], v232 offset:46080
v_rcp_f32 v197, v197
v_rcp_f32 v198, v198
v_mfma_f32_32x32x16_bf16 v[96:111], a[124:127], a[252:255], v[96:111]
ds_read_b128 a[192:195], v232 offset:47104
v_rcp_f32 v199, v199
v_fma_f32 v196, v196, v134, v132
v_fma_f32 v197, v197, v134, v132
s_waitcnt lgkmcnt(6)
v_mfma_f32_32x32x16_bf16 v[64:79], a[128:131], a[160:163], v[64:79]
ds_read_b128 a[196:199], v232 offset:49152
v_fma_f32 v198, v198, v134, v132
v_fma_f32 v199, v199, v134, v132
v_mul_f32 v196, v56, v196
v_mul_f32 v197, v57, v197
v_mul_f32 v198, v58, v198
v_mfma_f32_32x32x16_bf16 v[80:95], a[128:131], a[164:167], v[80:95]
ds_read_b128 a[200:203], v232 offset:50176
v_mul_f32 v199, v59, v199
v_cvt_pk_bf16_f32 v56, v196, v197
v_cvt_pk_bf16_f32 v57, v198, v199
v_mul_f32 v204, v60, v133
v_mul_f32 v205, v61, v133
v_mfma_f32_32x32x16_bf16 v[96:111], a[128:131], a[168:171], v[96:111]
ds_read_b128 a[204:207], v232 offset:51200
v_mul_f32 v206, v62, v133
v_mul_f32 v207, v63, v133
v_exp_f32 v204, v204
s_waitcnt lgkmcnt(6)
v_mfma_f32_32x32x16_bf16 v[64:79], a[132:135], a[172:175], v[64:79]
s_waitcnt vmcnt(6)
s_barrier
ds_read_b128 a[208:211], v233 offset:0
v_exp_f32 v205, v205
v_mfma_f32_32x32x16_bf16 v[80:95], a[132:135], a[176:179], v[80:95]
ds_read_b128 a[212:215], v233 offset:1024
v_exp_f32 v206, v206
v_exp_f32 v207, v207
v_add_f32 v208, 2.0, v204
v_mfma_f32_32x32x16_bf16 v[96:111], a[132:135], a[180:183], v[96:111]
ds_read_b128 a[216:219], v233 offset:2048
v_add_f32 v209, 2.0, v205
v_add_f32 v210, 2.0, v206
v_add_f32 v211, 2.0, v207
v_fma_f32 v204, v204, v208, 2.0
s_waitcnt lgkmcnt(6)
v_mfma_f32_32x32x16_bf16 v[64:79], a[136:139], a[184:187], v[64:79]
ds_read_b128 a[220:223], v233 offset:4096
v_fma_f32 v205, v205, v209, 2.0
v_fma_f32 v206, v206, v210, 2.0
v_fma_f32 v207, v207, v211, 2.0
v_rcp_f32 v204, v204
v_mfma_f32_32x32x16_bf16 v[80:95], a[136:139], a[188:191], v[80:95]
ds_read_b128 a[224:227], v233 offset:5120
v_rcp_f32 v205, v205
v_rcp_f32 v206, v206
v_mfma_f32_32x32x16_bf16 v[96:111], a[136:139], a[192:195], v[96:111]
ds_read_b128 a[228:231], v233 offset:6144
v_rcp_f32 v207, v207
v_fma_f32 v204, v204, v134, v132
v_fma_f32 v205, v205, v134, v132
s_waitcnt lgkmcnt(6)
v_mfma_f32_32x32x16_bf16 v[64:79], a[140:143], a[196:199], v[64:79]
ds_read_b128 a[232:235], v233 offset:8192
v_fma_f32 v206, v206, v134, v132
v_fma_f32 v207, v207, v134, v132
v_mul_f32 v204, v60, v204
v_mul_f32 v205, v61, v205
v_mul_f32 v206, v62, v206
v_mfma_f32_32x32x16_bf16 v[80:95], a[140:143], a[200:203], v[80:95]
ds_read_b128 a[236:239], v233 offset:9216
v_mul_f32 v207, v63, v207
v_cvt_pk_bf16_f32 v58, v204, v205
v_cvt_pk_bf16_f32 v59, v206, v207
v_mfma_f32_32x32x16_bf16 v[96:111], a[140:143], a[204:207], v[96:111]
buffer_store_dwordx4 v[56:59], v240, s[32:35], s68 offen offset:2560 sc1
ds_read_b128 a[240:243], v233 offset:10240
s_waitcnt lgkmcnt(6)
v_mfma_f32_32x32x16_bf16 v[64:79], a[144:147], a[208:211], v[64:79]
ds_read_b128 a[244:247], v233 offset:12288
v_mfma_f32_32x32x16_bf16 v[80:95], a[144:147], a[212:215], v[80:95]
ds_read_b128 a[248:251], v233 offset:13312
v_mfma_f32_32x32x16_bf16 v[96:111], a[144:147], a[216:219], v[96:111]
ds_read_b128 a[252:255], v233 offset:14336
s_waitcnt lgkmcnt(6)
v_mfma_f32_32x32x16_bf16 v[64:79], a[148:151], a[220:223], v[64:79]
v_mfma_f32_32x32x16_bf16 v[80:95], a[148:151], a[224:227], v[80:95]
v_mfma_f32_32x32x16_bf16 v[96:111], a[148:151], a[228:231], v[96:111]
s_waitcnt lgkmcnt(3)
v_mfma_f32_32x32x16_bf16 v[64:79], a[152:155], a[232:235], v[64:79]
ds_read_b128 a[160:163], v232 offset:3072
v_mfma_f32_32x32x16_bf16 v[80:95], a[152:155], a[236:239], v[80:95]
ds_read_b128 a[164:167], v232 offset:7168
v_mfma_f32_32x32x16_bf16 v[96:111], a[152:155], a[240:243], v[96:111]
ds_read_b128 a[168:171], v232 offset:11264
s_waitcnt lgkmcnt(3)
v_mfma_f32_32x32x16_bf16 v[64:79], a[156:159], a[244:247], v[64:79]
ds_read_b128 a[172:175], v232 offset:15360
v_mfma_f32_32x32x16_bf16 v[80:95], a[156:159], a[248:251], v[80:95]
ds_read_b128 a[176:179], v232 offset:19456
v_mfma_f32_32x32x16_bf16 v[96:111], a[156:159], a[252:255], v[96:111]
ds_read_b128 a[180:183], v232 offset:23552
v_mfma_f32_32x32x16_bf16 v[80:95], v[128:131], v[184:187], v[80:95]
ds_read_b128 a[184:187], v232 offset:31744
v_mfma_f32_32x32x16_bf16 v[64:79], v[128:131], v[180:183], v[64:79]
ds_read_b128 a[188:191], v232 offset:35840
v_mfma_f32_32x32x16_bf16 v[96:111], v[128:131], v[188:191], v[96:111]
ds_read_b128 a[192:195], v232 offset:39936
s_waitcnt lgkmcnt(6)
v_mfma_f32_32x32x16_bf16 v[112:127], a[160:163], a[96:99], v[112:127]
ds_read_b128 a[196:199], v232 offset:44032
s_nop 3
v_mul_f32 v196, v80, v136
v_mul_f32 v197, v81, v137
v_mul_f32 v198, v82, v138
v_mul_f32 v199, v83, v139
v_cvt_pk_bf16_f32 v212, v196, v197
v_mfma_f32_32x32x16_bf16 v[112:127], a[164:167], a[100:103], v[112:127]
ds_read_b128 a[200:203], v232 offset:48128
v_cvt_pk_bf16_f32 v213, v198, v199
v_mul_f32 v204, v84, v140
v_mul_f32 v205, v85, v141
v_mul_f32 v206, v86, v142
v_mul_f32 v207, v87, v143
v_mfma_f32_32x32x16_bf16 v[112:127], a[168:171], a[104:107], v[112:127]
s_add_u32 s84, s80, 20480
buffer_load_dwordx4 a[80:83], v232, s[32:35], s84 offen offset:0 sc1
ds_read_b128 a[204:207], v232 offset:52224
v_cvt_pk_bf16_f32 v214, v204, v205
v_cvt_pk_bf16_f32 v215, v206, v207
s_waitcnt lgkmcnt(6)
v_mfma_f32_32x32x16_bf16 v[112:127], a[172:175], a[108:111], v[112:127]
buffer_load_dwordx4 a[84:87], v232, s[32:35], s84 offen offset:1024 sc1
ds_read_b128 a[208:211], v233 offset:3072
ds_write_b128 v245, v[212:215] offset:2048
v_mul_f32 v196, v88, v144
v_mul_f32 v197, v89, v145
v_mul_f32 v198, v90, v146
v_mfma_f32_32x32x16_bf16 v[112:127], a[176:179], a[112:115], v[112:127]
buffer_load_dwordx4 a[88:91], v232, s[32:35], s84 offen offset:2048 sc1
ds_read_b128 a[212:215], v233 offset:7168
v_mul_f32 v199, v91, v147
v_cvt_pk_bf16_f32 v216, v196, v197
v_cvt_pk_bf16_f32 v217, v198, v199
v_mul_f32 v204, v92, v148
v_mfma_f32_32x32x16_bf16 v[112:127], a[180:183], a[116:119], v[112:127]
buffer_load_dwordx4 a[92:95], v232, s[32:35], s84 offen offset:3072 sc1
ds_read_b128 a[216:219], v233 offset:11264
v_mul_f32 v205, v93, v149
v_mul_f32 v206, v94, v150
v_mul_f32 v207, v95, v151
s_waitcnt lgkmcnt(7)
v_mfma_f32_32x32x16_bf16 v[112:127], a[184:187], a[120:123], v[112:127]
buffer_load_dwordx4 a[96:99], v249, s[32:35], s84 offen offset:0 sc1
ds_read_b128 a[220:223], v233 offset:15360
v_cvt_pk_bf16_f32 v218, v204, v205
v_cvt_pk_bf16_f32 v219, v206, v207
ds_write_b128 v245, v[216:219] offset:3072
v_fma_f32 v200, v64, v136, s69
v_mfma_f32_32x32x16_bf16 v[112:127], a[188:191], a[124:127], v[112:127]
s_add_u32 s84, s80, 25600
buffer_load_dwordx4 a[100:103], v232, s[32:35], s84 offen offset:0 sc1
v_fma_f32 v201, v65, v137, s69
v_fma_f32 v202, v66, v138, s69
v_fma_f32 v203, v67, v139, s69
v_fmaak_f32 v196, v200, v152, 0xbfb8aa47
v_mfma_f32_32x32x16_bf16 v[112:127], a[192:195], a[128:131], v[112:127]
buffer_load_dwordx4 a[104:107], v232, s[32:35], s84 offen offset:1024 sc1
v_fmaak_f32 v197, v201, v152, 0xbfb8aa47
v_fmaak_f32 v198, v202, v152, 0xbfb8aa47
v_fmaak_f32 v199, v203, v152, 0xbfb8aa47
s_waitcnt lgkmcnt(6)
v_mfma_f32_32x32x16_bf16 v[112:127], a[196:199], a[132:135], v[112:127]
buffer_load_dwordx4 a[108:111], v232, s[32:35], s84 offen offset:2048 sc1
v_exp_f32 v196, v196 clamp
v_exp_f32 v197, v197 clamp
v_mfma_f32_32x32x16_bf16 v[112:127], a[200:203], a[136:139], v[112:127]
buffer_load_dwordx4 a[112:115], v232, s[32:35], s84 offen offset:3072 sc1
v_exp_f32 v198, v198 clamp
v_exp_f32 v199, v199 clamp
v_add_f32 v196, s70, v196
v_mfma_f32_32x32x16_bf16 v[112:127], a[204:207], a[140:143], v[112:127]
buffer_load_dwordx4 a[116:119], v249, s[32:35], s84 offen offset:0 sc1
v_add_f32 v197, s70, v197
v_add_f32 v198, s70, v198
v_add_f32 v199, s70, v199
v_max_f32 v196, v196, v200
s_waitcnt lgkmcnt(2)
v_mfma_f32_32x32x16_bf16 v[112:127], a[208:211], a[144:147], v[112:127]
s_add_u32 s84, s80, 30720
buffer_load_dwordx4 a[120:123], v232, s[32:35], s84 offen offset:0 sc1
v_max_f32 v197, v197, v201
v_max_f32 v198, v198, v202
v_max_f32 v199, v199, v203
v_cvt_pk_bf16_f32 v212, v196, v197
v_mfma_f32_32x32x16_bf16 v[112:127], a[212:215], a[148:151], v[112:127]
buffer_load_dwordx4 a[124:127], v232, s[32:35], s84 offen offset:1024 sc1
v_cvt_pk_bf16_f32 v213, v198, v199
v_fma_f32 v208, v68, v140, s69
v_fma_f32 v209, v69, v141, s69
v_fma_f32 v210, v70, v142, s69
v_fma_f32 v211, v71, v143, s69
v_mfma_f32_32x32x16_bf16 v[112:127], a[216:219], a[152:155], v[112:127]
buffer_load_dwordx4 a[128:131], v232, s[32:35], s84 offen offset:2048 sc1
v_fmaak_f32 v204, v208, v152, 0xbfb8aa47
v_fmaak_f32 v205, v209, v152, 0xbfb8aa47
v_fmaak_f32 v206, v210, v152, 0xbfb8aa47
v_fmaak_f32 v207, v211, v152, 0xbfb8aa47
s_waitcnt lgkmcnt(1)
v_mfma_f32_32x32x16_bf16 v[112:127], a[220:223], a[156:159], v[112:127]
buffer_load_dwordx4 a[132:135], v232, s[32:35], s84 offen offset:3072 sc1
v_exp_f32 v204, v204 clamp
v_exp_f32 v205, v205 clamp
v_mfma_f32_32x32x16_bf16 v[112:127], v[192:195], v[128:131], v[112:127]
buffer_load_dwordx4 a[136:139], v249, s[32:35], s84 offen offset:0 sc1
v_exp_f32 v206, v206 clamp
v_exp_f32 v207, v207 clamp
v_add_f32 v204, s70, v204
s_waitcnt vmcnt(15)
s_add_u32 s84, s80, 35840
buffer_load_dwordx4 a[140:143], v232, s[32:35], s84 offen offset:0 sc1
s_waitcnt lgkmcnt(0)
s_barrier
buffer_store_dword v255, v254, s[32:35], 0 offen sc1
v_add_f32 v205, s70, v205
v_add_f32 v206, s70, v206
v_add_f32 v207, s70, v207
v_max_f32 v204, v204, v208
v_max_f32 v205, v205, v209
v_max_f32 v206, v206, v210
buffer_load_dwordx4 a[144:147], v232, s[32:35], s84 offen offset:1024 sc1
v_max_f32 v207, v207, v211
v_cvt_pk_bf16_f32 v214, v204, v205
v_cvt_pk_bf16_f32 v215, v206, v207
ds_write_b128 v245, v[212:215] offset:0
v_fma_f32 v200, v72, v144, s69
v_fma_f32 v201, v73, v145, s69
v_fma_f32 v202, v74, v146, s69
v_fma_f32 v203, v75, v147, s69
v_fmaak_f32 v196, v200, v152, 0xbfb8aa47
v_fmaak_f32 v197, v201, v152, 0xbfb8aa47
v_fmaak_f32 v198, v202, v152, 0xbfb8aa47
v_fmaak_f32 v199, v203, v152, 0xbfb8aa47
v_exp_f32 v196, v196 clamp
v_exp_f32 v197, v197 clamp
v_exp_f32 v198, v198 clamp
v_exp_f32 v199, v199 clamp
v_add_f32 v196, s70, v196
v_add_f32 v197, s70, v197
v_add_f32 v198, s70, v198
v_add_f32 v199, s70, v199
buffer_load_dwordx4 a[148:151], v232, s[32:35], s84 offen offset:2048 sc1
v_max_f32 v196, v196, v200
v_max_f32 v197, v197, v201
v_max_f32 v198, v198, v202
v_max_f32 v199, v199, v203
v_cvt_pk_bf16_f32 v216, v196, v197
v_cvt_pk_bf16_f32 v217, v198, v199
v_fma_f32 v208, v76, v148, s69
v_fma_f32 v209, v77, v149, s69
v_fma_f32 v210, v78, v150, s69
v_fma_f32 v211, v79, v151, s69
v_fmaak_f32 v204, v208, v152, 0xbfb8aa47
v_fmaak_f32 v205, v209, v152, 0xbfb8aa47
v_fmaak_f32 v206, v210, v152, 0xbfb8aa47
v_fmaak_f32 v207, v211, v152, 0xbfb8aa47
v_exp_f32 v204, v204 clamp
v_exp_f32 v205, v205 clamp
v_exp_f32 v206, v206 clamp
v_exp_f32 v207, v207 clamp
v_add_f32 v204, s70, v204
v_add_f32 v205, s70, v205
buffer_load_dwordx4 a[152:155], v232, s[32:35], s84 offen offset:3072 sc1
v_add_f32 v206, s70, v206
v_add_f32 v207, s70, v207
v_max_f32 v204, v204, v208
v_max_f32 v205, v205, v209
v_max_f32 v206, v206, v210
v_max_f32 v207, v207, v211
v_cvt_pk_bf16_f32 v218, v204, v205
v_cvt_pk_bf16_f32 v219, v206, v207
ds_write_b128 v245, v[216:219] offset:1024
v_fma_f32 v200, v96, v136, v153
v_fma_f32 v201, v97, v137, v153
v_fma_f32 v202, v98, v138, v153
v_fma_f32 v203, v99, v139, v153
v_fmaak_f32 v196, v200, v152, 0xbfb8aa47
v_fmaak_f32 v197, v201, v152, 0xbfb8aa47
v_fmaak_f32 v198, v202, v152, 0xbfb8aa47
v_fmaak_f32 v199, v203, v152, 0xbfb8aa47
v_exp_f32 v196, v196 clamp
v_exp_f32 v197, v197 clamp
v_exp_f32 v198, v198 clamp
v_exp_f32 v199, v199 clamp
buffer_load_dwordx4 a[156:159], v249, s[32:35], s84 offen offset:0 sc1
v_add_f32 v196, v154, v196
v_add_f32 v197, v154, v197
v_add_f32 v198, v154, v198
v_add_f32 v199, v154, v199
v_max_f32 v196, v196, v200
v_max_f32 v197, v197, v201
v_max_f32 v198, v198, v202
v_max_f32 v199, v199, v203
v_cvt_pk_bf16_f32 v212, v196, v197
v_cvt_pk_bf16_f32 v213, v198, v199
v_fma_f32 v208, v100, v140, v153
v_fma_f32 v209, v101, v141, v153
v_fma_f32 v210, v102, v142, v153
v_fma_f32 v211, v103, v143, v153
v_fmaak_f32 v204, v208, v152, 0xbfb8aa47
v_fmaak_f32 v205, v209, v152, 0xbfb8aa47
v_fmaak_f32 v206, v210, v152, 0xbfb8aa47
v_fmaak_f32 v207, v211, v152, 0xbfb8aa47
v_exp_f32 v204, v204 clamp
v_exp_f32 v205, v205 clamp
v_exp_f32 v206, v206 clamp
s_mul_i32 s84, s40, 13312
s_add_u32 m0, s84, 0
s_add_u32 s85, s80, 56320
buffer_load_dwordx4 v232, s[32:35], s85 offen offset:0 sc1 lds
v_exp_f32 v207, v207 clamp
v_add_f32 v204, v154, v204
v_add_f32 v205, v154, v205
v_add_f32 v206, v154, v206
v_add_f32 v207, v154, v207
v_max_f32 v204, v204, v208
v_max_f32 v205, v205, v209
v_max_f32 v206, v206, v210
v_max_f32 v207, v207, v211
v_cvt_pk_bf16_f32 v214, v204, v205
v_cvt_pk_bf16_f32 v215, v206, v207
ds_write_b128 v245, v[212:215] offset:4096
v_fma_f32 v200, v104, v144, v153
v_fma_f32 v201, v105, v145, v153
v_fma_f32 v202, v106, v146, v153
v_fma_f32 v203, v107, v147, v153
v_fmaak_f32 v196, v200, v152, 0xbfb8aa47
v_fmaak_f32 v197, v201, v152, 0xbfb8aa47
v_fmaak_f32 v198, v202, v152, 0xbfb8aa47
v_fmaak_f32 v199, v203, v152, 0xbfb8aa47
v_exp_f32 v196, v196 clamp
buffer_load_dwordx4 v232, s[32:35], s85 offen offset:1024 sc1 lds
v_exp_f32 v197, v197 clamp
v_exp_f32 v198, v198 clamp
v_exp_f32 v199, v199 clamp
v_add_f32 v196, v154, v196
v_add_f32 v197, v154, v197
v_add_f32 v198, v154, v198
v_add_f32 v199, v154, v199
v_max_f32 v196, v196, v200
v_max_f32 v197, v197, v201
v_max_f32 v198, v198, v202
v_max_f32 v199, v199, v203
v_cvt_pk_bf16_f32 v216, v196, v197
v_cvt_pk_bf16_f32 v217, v198, v199
v_fma_f32 v208, v108, v148, v153
v_fma_f32 v209, v109, v149, v153
v_fma_f32 v210, v110, v150, v153
v_fma_f32 v211, v111, v151, v153
v_fmaak_f32 v204, v208, v152, 0xbfb8aa47
v_fmaak_f32 v205, v209, v152, 0xbfb8aa47
v_fmaak_f32 v206, v210, v152, 0xbfb8aa47
v_fmaak_f32 v207, v211, v152, 0xbfb8aa47
buffer_load_dwordx4 v232, s[32:35], s85 offen offset:2048 sc1 lds
v_exp_f32 v204, v204 clamp
v_exp_f32 v205, v205 clamp
v_exp_f32 v206, v206 clamp
v_exp_f32 v207, v207 clamp
v_add_f32 v204, v154, v204
v_add_f32 v205, v154, v205
v_add_f32 v206, v154, v206
v_add_f32 v207, v154, v207
v_max_f32 v204, v204, v208
v_max_f32 v205, v205, v209
v_max_f32 v206, v206, v210
v_max_f32 v207, v207, v211
v_cvt_pk_bf16_f32 v218, v204, v205
v_cvt_pk_bf16_f32 v219, v206, v207
ds_write_b128 v245, v[216:219] offset:5120
v_mov_b32 v16, 0
v_mov_b32 v17, 0
v_mov_b32 v18, 0
v_mov_b32 v19, 0
ds_write_b128 v135, v[16:19]
buffer_load_dwordx4 v232, s[32:35], s85 offen offset:3072 sc1 lds
s_waitcnt lgkmcnt(0)
s_barrier
ds_read_b128 a[160:163], v246 offset:0
ds_read_b128 a[164:167], v247 offset:0
ds_read_b128 a[168:171], v246 offset:1024
ds_read_b128 a[172:175], v247 offset:1024
ds_read_b128 a[176:179], v246 offset:6144
ds_read_b128 a[180:183], v247 offset:6144
ds_read_b128 a[184:187], v246 offset:7168
ds_read_b128 a[188:191], v247 offset:7168
ds_read_b128 a[192:195], v246 offset:12288
ds_read_b128 a[196:199], v247 offset:12288
s_mul_i32 s84, s40, 13312
s_add_u32 m0, s84, 4096
s_add_u32 s85, s80, 60416
buffer_load_dwordx4 v232, s[32:35], s85 offen offset:0 sc1 lds
ds_read_b128 a[200:203], v246 offset:13312
ds_read_b128 a[204:207], v247 offset:13312
ds_read_b128 a[208:211], v246 offset:18432
ds_read_b128 a[212:215], v247 offset:18432
ds_read_b128 a[216:219], v246 offset:19456
ds_read_b128 a[220:223], v247 offset:19456
ds_read_b64_tr_b16 v[228:229], v248
ds_read_b64_tr_b16 v[230:231], v248 offset:64
s_waitcnt lgkmcnt(15)
v_mfma_f32_32x32x16_bf16 v[96:111], a[160:163], a[164:167], 0
v_fma_f32 v200, v112, v132, s69
v_fma_f32 v201, v113, v132, s69
v_fma_f32 v202, v114, v132, s69
v_fma_f32 v203, v115, v132, s69
v_fmaak_f32 v196, v200, v152, 0xbfb8aa47
s_mul_i32 s84, s40, 13312
s_add_u32 m0, s84, 5120
s_add_u32 s85, s82, 0
buffer_load_dwordx4 v232, s[32:35], s85 offen offset:0 sc1 lds
v_fmaak_f32 v197, v201, v152, 0xbfb8aa47
s_waitcnt lgkmcnt(14)
v_mfma_f32_32x32x16_bf16 v[96:111], a[168:171], a[172:175], v[96:111]
v_fmaak_f32 v198, v202, v152, 0xbfb8aa47
v_fmaak_f32 v199, v203, v152, 0xbfb8aa47
v_exp_f32 v196, v196 clamp
v_exp_f32 v197, v197 clamp
s_waitcnt lgkmcnt(12)
v_mfma_f32_32x32x16_bf16 v[96:111], a[176:179], a[180:183], v[96:111]
buffer_load_dwordx4 v232, s[32:35], s85 offen offset:1024 sc1 lds
v_exp_f32 v198, v198 clamp
v_exp_f32 v199, v199 clamp
v_add_f32 v196, s70, v196
v_add_f32 v197, s70, v197
s_waitcnt lgkmcnt(10)
v_mfma_f32_32x32x16_bf16 v[96:111], a[184:187], a[188:191], v[96:111]
v_add_f32 v198, s70, v198
v_add_f32 v199, s70, v199
v_max_f32 v196, v196, v200
buffer_load_dwordx4 v232, s[32:35], s85 offen offset:2048 sc1 lds
v_max_f32 v197, v197, v201
v_max_f32 v198, v198, v202
v_max_f32 v199, v199, v203
s_waitcnt lgkmcnt(8)
v_mfma_f32_32x32x16_bf16 v[96:111], a[192:195], a[196:199], v[96:111]
v_cvt_pk_bf16_f32 v220, v196, v197
v_cvt_pk_bf16_f32 v221, v198, v199
v_fma_f32 v208, v116, v132, s69
v_fma_f32 v209, v117, v132, s69
v_fma_f32 v210, v118, v132, s69
v_fma_f32 v211, v119, v132, s69
s_waitcnt lgkmcnt(6)
v_mfma_f32_32x32x16_bf16 v[96:111], a[200:203], a[204:207], v[96:111]
buffer_load_dwordx4 v232, s[32:35], s85 offen offset:3072 sc1 lds
v_fmaak_f32 v204, v208, v152, 0xbfb8aa47
v_fmaak_f32 v205, v209, v152, 0xbfb8aa47
v_fmaak_f32 v206, v210, v152, 0xbfb8aa47
v_fmaak_f32 v207, v211, v152, 0xbfb8aa47
v_exp_f32 v204, v204 clamp
s_waitcnt lgkmcnt(4)
v_mfma_f32_32x32x16_bf16 v[96:111], a[208:211], a[212:215], v[96:111]
v_exp_f32 v205, v205 clamp
s_mul_i32 s84, s40, 13312
s_add_u32 m0, s84, 9216
s_add_u32 s85, s82, 4096
buffer_load_dwordx4 v232, s[32:35], s85 offen offset:0 sc1 lds
v_exp_f32 v206, v206 clamp
v_exp_f32 v207, v207 clamp
s_waitcnt lgkmcnt(2)
v_mfma_f32_32x32x16_bf16 v[96:111], a[216:219], a[220:223], v[96:111]
v_add_f32 v204, s70, v204
v_add_f32 v205, s70, v205
v_add_f32 v206, s70, v206
v_add_f32 v207, s70, v207
v_max_f32 v204, v204, v208
v_max_f32 v205, v205, v209
s_waitcnt lgkmcnt(0)
s_lshr_b32 s45, s43, 1
s_lshl_b32 s45, s45, 7
s_load_dwordx16 s[48:63], s[32:33], s45
buffer_load_dwordx4 v232, s[32:35], s85 offen offset:1024 sc1 lds
v_max_f32 v206, v206, v210
v_max_f32 v207, v207, v211
v_cvt_pk_bf16_f32 v222, v204, v205
v_cvt_pk_bf16_f32 v223, v206, v207
v_fma_f32 v200, v120, v132, s69
v_fma_f32 v201, v121, v132, s69
v_fma_f32 v202, v122, v132, s69
v_fma_f32 v203, v123, v132, s69
v_fmaak_f32 v196, v200, v152, 0xbfb8aa47
v_fmaak_f32 v197, v201, v152, 0xbfb8aa47
v_fmaak_f32 v198, v202, v152, 0xbfb8aa47
v_fmaak_f32 v199, v203, v152, 0xbfb8aa47
v_min_u32 v96, -2, v96
buffer_store_dwordx4 v[96:99], v241, s[32:35], s72 offen sc1
v_min_u32 v100, -2, v100
buffer_store_dwordx4 v[100:103], v242, s[32:35], s72 offen sc1
v_min_u32 v104, -2, v104
buffer_store_dwordx4 v[104:107], v243, s[32:35], s72 offen sc1
v_min_u32 v108, -2, v108
buffer_store_dwordx4 v[108:111], v244, s[32:35], s72 offen sc1
v_exp_f32 v196, v196 clamp
v_exp_f32 v197, v197 clamp
v_exp_f32 v198, v198 clamp
v_exp_f32 v199, v199 clamp
v_add_f32 v196, s70, v196
v_add_f32 v197, s70, v197
v_add_f32 v198, s70, v198
v_add_f32 v199, s70, v199
v_max_f32 v196, v196, v200
v_max_f32 v197, v197, v201
v_max_f32 v198, v198, v202
v_max_f32 v199, v199, v203
v_cvt_pk_bf16_f32 v224, v196, v197
v_cvt_pk_bf16_f32 v225, v198, v199
v_fma_f32 v208, v124, v132, s69
v_fma_f32 v209, v125, v132, s69
v_fma_f32 v210, v126, v132, s69
v_fma_f32 v211, v127, v132, s69
v_fmaak_f32 v204, v208, v152, 0xbfb8aa47
v_fmaak_f32 v205, v209, v152, 0xbfb8aa47
v_fmaak_f32 v206, v210, v152, 0xbfb8aa47
v_fmaak_f32 v207, v211, v152, 0xbfb8aa47
v_exp_f32 v204, v204 clamp
v_exp_f32 v205, v205 clamp
v_exp_f32 v206, v206 clamp
v_exp_f32 v207, v207 clamp
v_add_f32 v204, s70, v204
v_add_f32 v205, s70, v205
v_add_f32 v206, s70, v206
v_add_f32 v207, s70, v207
v_max_f32 v204, v204, v208
v_max_f32 v205, v205, v209
v_max_f32 v206, v206, v210
v_max_f32 v207, v207, v211
v_cvt_pk_bf16_f32 v226, v204, v205
v_cvt_pk_bf16_f32 v227, v206, v207
s_lshl_b32 s45, s40, 6
v_add_u32 v20, s45, v0
v_min_u32 v20, 209, v20
v_lshlrev_b32 v237, 4, v20
v_mul_u32_u24 v21, 0x3334, v20
v_lshrrev_b32 v21, 16, v21
v_mul_u32_u24 v22, 5, v21
v_sub_u32 v22, v20, v22
v_cmp_le_u32 vcc, 21, v21
s_nop 1
v_cndmask_b32 v23, 0, 1, vcc
v_mul_u32_u24 v20, 21, v23
v_sub_u32 v21, v21, v20
v_mul_u32_u24 v23, 5, v23
v_add_u32 v22, v22, v23
v_lshlrev_b32 v22, 2, v22
s_mov_b32 s46, 3114545440
s_mov_b32 s47, 220
v_lshrrev_b64 v[24:25], v22, s[46:47]
v_and_b32 v22, 15, v24
v_mul_u32_u24 v21, 144, v21
v_lshl_add_u32 v21, v22, 3, v21
v_add_u32 v238, 159744, v21
v_and_b32 v20, 31, v0
v_min_u32 v20, 20, v20
v_mul_u32_u24 v20, 144, v20
v_lshrrev_b32 v22, 5, v0
v_lshl_add_u32 v20, v22, 4, v20
v_add_u32 v239, 159744, v20
s_add_u32 s45, s40, 1
s_and_b32 s45, s45, 3
s_mul_i32 s45, s45, 5120
s_add_u32 s45, s45, 0
v_add_u32 v1, s45, v232
s_add_u32 s45, s40, 2
s_and_b32 s45, s45, 3
s_mul_i32 s45, s45, 5120
s_add_u32 s45, s45, 20480
v_add_u32 v7, s45, v232
s_add_u32 s45, s40, 3
buffer_load_dwordx4 v232, s[32:35], s85 offen offset:2048 sc1 lds
s_and_b32 s45, s45, 3
s_mul_i32 s45, s45, 5120
s_add_u32 s45, s45, 86016
v_add_u32 v8, s45, v232
s_mul_i32 s45, s40, 5120
v_add_u32 v2, s45, v232
v_add_u32 v9, 86016, v2
v_and_b32 v10, 15, v0
v_mul_u32_u24 v10, 1280, v10
v_lshrrev_b32 v11, 4, v0
v_lshl_add_u32 v3, v11, 3, v10
v_and_b32 v11, 1, v11
v_lshl_add_u32 v10, v11, 5, v10
v_lshrrev_b32 v11, 5, v0
v_lshl_add_u32 v14, v11, 4, v10
s_mul_i32 s45, s40, 11264
s_add_u32 s45, s45, 114688
v_add_u32 v4, s45, v232
s_lshl_b32 s45, s40, 10
s_add_u32 s45, s45, 53248
v_add_u32 v5, s45, v232
s_mul_i32 s45, s40, 13312
v_add_u32 v6, s45, v232
buffer_load_dwordx4 v232, s[32:35], s85 offen offset:3072 sc1 lds
buffer_load_dwordx2 v[180:181], v3, s[4:7], s83 offen offset:0
buffer_load_dwordx2 v[182:183], v3, s[4:7], s83 offen offset:32
buffer_load_dwordx2 v[184:185], v3, s[4:7], s83 offen offset:64
buffer_load_dwordx2 v[186:187], v3, s[4:7], s83 offen offset:96
buffer_load_dwordx2 v[188:189], v3, s[4:7], s83 offen offset:128
s_waitcnt lgkmcnt(0)
s_and_b64 s[48:49], s[48:49], s[50:51]
s_and_b64 s[48:49], s[48:49], s[52:53]
s_and_b64 s[48:49], s[48:49], s[54:55]
s_and_b64 s[48:49], s[48:49], s[56:57]
s_and_b64 s[48:49], s[48:49], s[58:59]
s_and_b64 s[48:49], s[48:49], s[60:61]
s_and_b64 s[48:49], s[48:49], s[62:63]
s_and_b32 s48, s48, s49
s_bitcmp1_b32 s48, 1
s_cbranch_scc0 L_fb_h2
L_ok_h2:
s_add_u32 s85, s79, 0
buffer_load_dwordx4 a[224:227], v253, s[32:35], s85 offen offset:0 sc1
buffer_load_dwordx4 a[228:231], v250, s[32:35], s85 offen offset:0 sc1
buffer_load_dwordx4 a[232:235], v251, s[32:35], s85 offen offset:0 sc1
buffer_load_dwordx4 a[236:239], v252, s[32:35], s85 offen offset:0 sc1
s_add_u32 s85, s79, 0
buffer_load_dwordx4 a[240:243], v253, s[32:35], s85 offen offset:1024 sc1
buffer_load_dwordx4 a[244:247], v250, s[32:35], s85 offen offset:1024 sc1
buffer_load_dwordx4 a[248:251], v251, s[32:35], s85 offen offset:1024 sc1
buffer_load_dwordx4 a[252:255], v252, s[32:35], s85 offen offset:1024 sc1
s_add_u32 s85, s79, 0
buffer_load_dwordx4 a[160:163], v253, s[32:35], s85 offen offset:2048 sc1
buffer_load_dwordx4 a[164:167], v250, s[32:35], s85 offen offset:2048 sc1
buffer_load_dwordx4 a[168:171], v251, s[32:35], s85 offen offset:2048 sc1
buffer_load_dwordx4 a[172:175], v252, s[32:35], s85 offen offset:2048 sc1
s_waitcnt vmcnt(16)
v_lshlrev_b32 v28, 16, v180
v_and_b32 v29, 0xffff0000, v180
v_lshlrev_b32 v30, 16, v181
v_and_b32 v31, 0xffff0000, v181
s_waitcnt vmcnt(15)
v_lshlrev_b32 v44, 16, v182
v_and_b32 v45, 0xffff0000, v182
v_lshlrev_b32 v46, 16, v183
v_and_b32 v47, 0xffff0000, v183
s_waitcnt vmcnt(14)
v_lshlrev_b32 v60, 16, v184
v_and_b32 v61, 0xffff0000, v184
v_lshlrev_b32 v62, 16, v185
v_and_b32 v63, 0xffff0000, v185
s_waitcnt vmcnt(13)
v_lshlrev_b32 v76, 16, v186
v_and_b32 v77, 0xffff0000, v186
v_lshlrev_b32 v78, 16, v187
v_and_b32 v79, 0xffff0000, v187
s_waitcnt vmcnt(12)
v_lshlrev_b32 v92, 16, v188
v_and_b32 v93, 0xffff0000, v188
v_lshlrev_b32 v94, 16, v189
v_and_b32 v95, 0xffff0000, v189
s_waitcnt vmcnt(11)
v_mfma_f32_16x16x32_bf16 v[16:19], a[0:3], a[224:227], 0
v_mfma_f32_16x16x32_bf16 v[32:35], a[4:7], a[224:227], 0
v_mfma_f32_16x16x32_bf16 v[48:51], a[8:11], a[224:227], 0
v_mfma_f32_16x16x32_bf16 v[64:67], a[12:15], a[224:227], 0
v_mfma_f32_16x16x32_bf16 v[80:83], a[16:19], a[224:227], 0
s_waitcnt vmcnt(10)
v_mfma_f32_16x16x32_bf16 v[20:23], a[0:3], a[228:231], 0
v_mfma_f32_16x16x32_bf16 v[36:39], a[4:7], a[228:231], 0
v_mfma_f32_16x16x32_bf16 v[52:55], a[8:11], a[228:231], 0
v_mfma_f32_16x16x32_bf16 v[68:71], a[12:15], a[228:231], 0
v_mfma_f32_16x16x32_bf16 v[84:87], a[16:19], a[228:231], 0
s_waitcnt vmcnt(9)
v_mfma_f32_16x16x32_bf16 v[24:27], a[0:3], a[232:235], 0
v_mfma_f32_16x16x32_bf16 v[40:43], a[4:7], a[232:235], 0
s_add_u32 s85, s79, 3072
buffer_load_dwordx4 a[176:179], v253, s[32:35], s85 offen offset:0 sc1
v_mfma_f32_16x16x32_bf16 v[56:59], a[8:11], a[232:235], 0
v_mfma_f32_16x16x32_bf16 v[72:75], a[12:15], a[232:235], 0
v_mfma_f32_16x16x32_bf16 v[88:91], a[16:19], a[232:235], 0
buffer_load_dwordx4 a[180:183], v250, s[32:35], s85 offen offset:0 sc1
s_waitcnt vmcnt(10)
v_mfma_f32_16x16x32_bf16 v[28:31], a[0:3], a[236:239], v[28:31]
v_mfma_f32_16x16x32_bf16 v[44:47], a[4:7], a[236:239], v[44:47]
v_mfma_f32_16x16x32_bf16 v[60:63], a[8:11], a[236:239], v[60:63]
buffer_load_dwordx4 a[184:187], v251, s[32:35], s85 offen offset:0 sc1
v_mfma_f32_16x16x32_bf16 v[76:79], a[12:15], a[236:239], v[76:79]
v_mfma_f32_16x16x32_bf16 v[92:95], a[16:19], a[236:239], v[92:95]
s_waitcnt vmcnt(10)
v_mfma_f32_16x16x32_bf16 v[16:19], a[20:23], a[240:243], v[16:19]
v_mfma_f32_16x16x32_bf16 v[32:35], a[24:27], a[240:243], v[32:35]
buffer_load_dwordx4 a[188:191], v252, s[32:35], s85 offen offset:0 sc1
v_mfma_f32_16x16x32_bf16 v[48:51], a[28:31], a[240:243], v[48:51]
v_mfma_f32_16x16x32_bf16 v[64:67], a[32:35], a[240:243], v[64:67]
v_mfma_f32_16x16x32_bf16 v[80:83], a[36:39], a[240:243], v[80:83]
s_add_u32 s85, s79, 3072
buffer_load_dwordx4 a[192:195], v253, s[32:35], s85 offen offset:1024 sc1
s_waitcnt vmcnt(11)
v_mfma_f32_16x16x32_bf16 v[20:23], a[20:23], a[244:247], v[20:23]
v_mfma_f32_16x16x32_bf16 v[36:39], a[24:27], a[244:247], v[36:39]
v_mfma_f32_16x16x32_bf16 v[52:55], a[28:31], a[244:247], v[52:55]
buffer_load_dwordx4 a[196:199], v250, s[32:35], s85 offen offset:1024 sc1
v_mfma_f32_16x16x32_bf16 v[68:71], a[32:35], a[244:247], v[68:71]
v_mfma_f32_16x16x32_bf16 v[84:87], a[36:39], a[244:247], v[84:87]
s_waitcnt vmcnt(11)
v_mfma_f32_16x16x32_bf16 v[24:27], a[20:23], a[248:251], v[24:27]
buffer_load_dwordx4 a[200:203], v251, s[32:35], s85 offen offset:1024 sc1
v_mfma_f32_16x16x32_bf16 v[40:43], a[24:27], a[248:251], v[40:43]
v_mfma_f32_16x16x32_bf16 v[56:59], a[28:31], a[248:251], v[56:59]
v_mfma_f32_16x16x32_bf16 v[72:75], a[32:35], a[248:251], v[72:75]
v_mfma_f32_16x16x32_bf16 v[88:91], a[36:39], a[248:251], v[88:91]
buffer_load_dwordx4 a[204:207], v252, s[32:35], s85 offen offset:1024 sc1
s_waitcnt vmcnt(12)
v_mfma_f32_16x16x32_bf16 v[28:31], a[20:23], a[252:255], v[28:31]
v_mfma_f32_16x16x32_bf16 v[44:47], a[24:27], a[252:255], v[44:47]
v_mfma_f32_16x16x32_bf16 v[60:63], a[28:31], a[252:255], v[60:63]
s_add_u32 s85, s79, 3072
buffer_load_dwordx4 a[208:211], v253, s[32:35], s85 offen offset:2048 sc1
v_mfma_f32_16x16x32_bf16 v[76:79], a[32:35], a[252:255], v[76:79]
v_mfma_f32_16x16x32_bf16 v[92:95], a[36:39], a[252:255], v[92:95]
s_waitcnt vmcnt(12)
v_mfma_f32_16x16x32_bf16 v[16:19], a[40:43], a[160:163], v[16:19]
buffer_load_dwordx4 a[212:215], v250, s[32:35], s85 offen offset:2048 sc1
v_mfma_f32_16x16x32_bf16 v[32:35], a[44:47], a[160:163], v[32:35]
v_mfma_f32_16x16x32_bf16 v[48:51], a[48:51], a[160:163], v[48:51]
v_mfma_f32_16x16x32_bf16 v[64:67], a[52:55], a[160:163], v[64:67]
v_mfma_f32_16x16x32_bf16 v[80:83], a[56:59], a[160:163], v[80:83]
buffer_load_dwordx4 a[216:219], v251, s[32:35], s85 offen offset:2048 sc1
s_waitcnt vmcnt(13)
v_mfma_f32_16x16x32_bf16 v[20:23], a[40:43], a[164:167], v[20:23]
v_mfma_f32_16x16x32_bf16 v[36:39], a[44:47], a[164:167], v[36:39]
v_mfma_f32_16x16x32_bf16 v[52:55], a[48:51], a[164:167], v[52:55]
buffer_load_dwordx4 a[220:223], v252, s[32:35], s85 offen offset:2048 sc1
v_mfma_f32_16x16x32_bf16 v[68:71], a[52:55], a[164:167], v[68:71]
v_mfma_f32_16x16x32_bf16 v[84:87], a[56:59], a[164:167], v[84:87]
s_waitcnt vmcnt(13)
v_mfma_f32_16x16x32_bf16 v[24:27], a[40:43], a[168:171], v[24:27]
s_mul_i32 s78, s42, 57344
s_add_u32 s78, s78, 14667776
buffer_load_dwordx4 v[100:103], v237, s[32:35], s78 offen offset:0 sc1
v_mfma_f32_16x16x32_bf16 v[40:43], a[44:47], a[168:171], v[40:43]
v_mfma_f32_16x16x32_bf16 v[56:59], a[48:51], a[168:171], v[56:59]
v_mfma_f32_16x16x32_bf16 v[72:75], a[52:55], a[168:171], v[72:75]
buffer_load_dwordx4 v[104:107], v237, s[32:35], s78 offen offset:3584 sc1
v_mfma_f32_16x16x32_bf16 v[88:91], a[56:59], a[168:171], v[88:91]
s_waitcnt vmcnt(14)
v_mfma_f32_16x16x32_bf16 v[28:31], a[40:43], a[172:175], v[28:31]
v_mfma_f32_16x16x32_bf16 v[44:47], a[44:47], a[172:175], v[44:47]
s_add_u32 s78, s78, 7168
buffer_load_dwordx4 v[108:111], v237, s[32:35], s78 offen offset:0 sc1
v_mfma_f32_16x16x32_bf16 v[60:63], a[48:51], a[172:175], v[60:63]
v_mfma_f32_16x16x32_bf16 v[76:79], a[52:55], a[172:175], v[76:79]
v_mfma_f32_16x16x32_bf16 v[92:95], a[56:59], a[172:175], v[92:95]
buffer_load_dwordx4 v[112:115], v237, s[32:35], s78 offen offset:3584 sc1
s_waitcnt vmcnt(15)
v_mfma_f32_16x16x32_bf16 v[16:19], a[60:63], a[176:179], v[16:19]
v_mfma_f32_16x16x32_bf16 v[32:35], a[64:67], a[176:179], v[32:35]
v_mfma_f32_16x16x32_bf16 v[48:51], a[68:71], a[176:179], v[48:51]
s_add_u32 s78, s78, 7168
buffer_load_dwordx4 v[116:119], v237, s[32:35], s78 offen offset:0 sc1
v_mfma_f32_16x16x32_bf16 v[64:67], a[72:75], a[176:179], v[64:67]
v_mfma_f32_16x16x32_bf16 v[80:83], a[76:79], a[176:179], v[80:83]
buffer_load_dwordx4 v[120:123], v237, s[32:35], s78 offen offset:3584 sc1
s_waitcnt vmcnt(16)
v_mfma_f32_16x16x32_bf16 v[20:23], a[60:63], a[180:183], v[20:23]
v_mfma_f32_16x16x32_bf16 v[36:39], a[64:67], a[180:183], v[36:39]
v_mfma_f32_16x16x32_bf16 v[52:55], a[68:71], a[180:183], v[52:55]
s_add_u32 s78, s78, 7168
buffer_load_dwordx4 v[124:127], v237, s[32:35], s78 offen offset:0 sc1
v_mfma_f32_16x16x32_bf16 v[68:71], a[72:75], a[180:183], v[68:71]
v_mfma_f32_16x16x32_bf16 v[84:87], a[76:79], a[180:183], v[84:87]
s_waitcnt vmcnt(16)
v_mfma_f32_16x16x32_bf16 v[24:27], a[60:63], a[184:187], v[24:27]
buffer_load_dwordx4 v[128:131], v237, s[32:35], s78 offen offset:3584 sc1
v_mfma_f32_16x16x32_bf16 v[40:43], a[64:67], a[184:187], v[40:43]
v_mfma_f32_16x16x32_bf16 v[56:59], a[68:71], a[184:187], v[56:59]
v_mfma_f32_16x16x32_bf16 v[72:75], a[72:75], a[184:187], v[72:75]
s_add_u32 s78, s78, 7168
buffer_load_dwordx4 v[132:135], v237, s[32:35], s78 offen offset:0 sc1
v_mfma_f32_16x16x32_bf16 v[88:91], a[76:79], a[184:187], v[88:91]
s_waitcnt vmcnt(17)
v_mfma_f32_16x16x32_bf16 v[28:31], a[60:63], a[188:191], v[28:31]
v_mfma_f32_16x16x32_bf16 v[44:47], a[64:67], a[188:191], v[44:47]
buffer_load_dwordx4 v[136:139], v237, s[32:35], s78 offen offset:3584 sc1
v_mfma_f32_16x16x32_bf16 v[60:63], a[68:71], a[188:191], v[60:63]
v_mfma_f32_16x16x32_bf16 v[76:79], a[72:75], a[188:191], v[76:79]
v_mfma_f32_16x16x32_bf16 v[92:95], a[76:79], a[188:191], v[92:95]
s_add_u32 s78, s78, 7168
buffer_load_dwordx4 v[140:143], v237, s[32:35], s78 offen offset:0 sc1
s_waitcnt vmcnt(18)
v_mfma_f32_16x16x32_bf16 v[16:19], a[80:83], a[192:195], v[16:19]
v_mfma_f32_16x16x32_bf16 v[32:35], a[84:87], a[192:195], v[32:35]
v_mfma_f32_16x16x32_bf16 v[48:51], a[88:91], a[192:195], v[48:51]
buffer_load_dwordx4 v[144:147], v237, s[32:35], s78 offen offset:3584 sc1
v_mfma_f32_16x16x32_bf16 v[64:67], a[92:95], a[192:195], v[64:67]
v_mfma_f32_16x16x32_bf16 v[80:83], a[96:99], a[192:195], v[80:83]
s_waitcnt vmcnt(18)
v_mfma_f32_16x16x32_bf16 v[20:23], a[80:83], a[196:199], v[20:23]
s_add_u32 s78, s78, 7168
buffer_load_dwordx4 v[148:151], v237, s[32:35], s78 offen offset:0 sc1
v_mfma_f32_16x16x32_bf16 v[36:39], a[84:87], a[196:199], v[36:39]
v_mfma_f32_16x16x32_bf16 v[52:55], a[88:91], a[196:199], v[52:55]
v_mfma_f32_16x16x32_bf16 v[68:71], a[92:95], a[196:199], v[68:71]
buffer_load_dwordx4 v[152:155], v237, s[32:35], s78 offen offset:3584 sc1
v_mfma_f32_16x16x32_bf16 v[84:87], a[96:99], a[196:199], v[84:87]
s_waitcnt vmcnt(19)
v_mfma_f32_16x16x32_bf16 v[24:27], a[80:83], a[200:203], v[24:27]
v_mfma_f32_16x16x32_bf16 v[40:43], a[84:87], a[200:203], v[40:43]
s_add_u32 s78, s78, 7168
buffer_load_dwordx4 v[156:159], v237, s[32:35], s78 offen offset:0 sc1
v_mfma_f32_16x16x32_bf16 v[56:59], a[88:91], a[200:203], v[56:59]
v_mfma_f32_16x16x32_bf16 v[72:75], a[92:95], a[200:203], v[72:75]
v_mfma_f32_16x16x32_bf16 v[88:91], a[96:99], a[200:203], v[88:91]
buffer_load_dwordx4 v[160:163], v237, s[32:35], s78 offen offset:3584 sc1
s_waitcnt vmcnt(20)
v_mfma_f32_16x16x32_bf16 v[28:31], a[80:83], a[204:207], v[28:31]
v_mfma_f32_16x16x32_bf16 v[44:47], a[84:87], a[204:207], v[44:47]
s_mul_i32 s84, s40, 1024
s_add_u32 m0, s84, 57344
s_add_u32 s85, s82, 8192
buffer_load_dwordx4 v232, s[32:35], s85 offen offset:0 sc1 lds
v_mfma_f32_16x16x32_bf16 v[60:63], a[88:91], a[204:207], v[60:63]
v_mfma_f32_16x16x32_bf16 v[76:79], a[92:95], a[204:207], v[76:79]
v_mfma_f32_16x16x32_bf16 v[92:95], a[96:99], a[204:207], v[92:95]
s_mul_i32 s84, s40, 1024
s_add_u32 m0, s84, 61440
s_add_u32 s85, s82, 9216
buffer_load_dwordx4 v232, s[32:35], s85 offen offset:0 sc1 lds
s_waitcnt vmcnt(21)
v_mfma_f32_16x16x32_bf16 v[16:19], a[100:103], a[208:211], v[16:19]
v_mfma_f32_16x16x32_bf16 v[32:35], a[104:107], a[208:211], v[32:35]
v_mfma_f32_16x16x32_bf16 v[48:51], a[108:111], a[208:211], v[48:51]
s_add_u32 s85, s79, 6144
buffer_load_dwordx4 a[224:227], v253, s[32:35], s85 offen offset:0 sc1
v_mfma_f32_16x16x32_bf16 v[64:67], a[112:115], a[208:211], v[64:67]
v_mfma_f32_16x16x32_bf16 v[80:83], a[116:119], a[208:211], v[80:83]
s_waitcnt vmcnt(21)
v_mfma_f32_16x16x32_bf16 v[20:23], a[100:103], a[212:215], v[20:23]
v_mfma_f32_16x16x32_bf16 v[36:39], a[104:107], a[212:215], v[36:39]
buffer_load_dwordx4 a[228:231], v250, s[32:35], s85 offen offset:0 sc1
v_mfma_f32_16x16x32_bf16 v[52:55], a[108:111], a[212:215], v[52:55]
v_mfma_f32_16x16x32_bf16 v[68:71], a[112:115], a[212:215], v[68:71]
v_mfma_f32_16x16x32_bf16 v[84:87], a[116:119], a[212:215], v[84:87]
buffer_load_dwordx4 a[232:235], v251, s[32:35], s85 offen offset:0 sc1
s_waitcnt vmcnt(22)
v_mfma_f32_16x16x32_bf16 v[24:27], a[100:103], a[216:219], v[24:27]
v_mfma_f32_16x16x32_bf16 v[40:43], a[104:107], a[216:219], v[40:43]
v_mfma_f32_16x16x32_bf16 v[56:59], a[108:111], a[216:219], v[56:59]
buffer_load_dwordx4 a[236:239], v252, s[32:35], s85 offen offset:0 sc1
v_mfma_f32_16x16x32_bf16 v[72:75], a[112:115], a[216:219], v[72:75]
v_mfma_f32_16x16x32_bf16 v[88:91], a[116:119], a[216:219], v[88:91]
s_waitcnt vmcnt(22)
v_mfma_f32_16x16x32_bf16 v[28:31], a[100:103], a[220:223], v[28:31]
s_add_u32 s85, s79, 6144
buffer_load_dwordx4 a[240:243], v253, s[32:35], s85 offen offset:1024 sc1
v_mfma_f32_16x16x32_bf16 v[44:47], a[104:107], a[220:223], v[44:47]
v_mfma_f32_16x16x32_bf16 v[60:63], a[108:111], a[220:223], v[60:63]
v_mfma_f32_16x16x32_bf16 v[76:79], a[112:115], a[220:223], v[76:79]
v_mfma_f32_16x16x32_bf16 v[92:95], a[116:119], a[220:223], v[92:95]
buffer_load_dwordx4 a[244:247], v250, s[32:35], s85 offen offset:1024 sc1
s_waitcnt vmcnt(8)
v_max3_u32 v196, v100, v104, v108
v_max3_u32 v196, v196, v112, v116
v_max3_u32 v196, v196, v120, v124
v_max3_u32 v196, v196, v128, v132
v_max3_u32 v196, v196, v136, v140
v_max3_u32 v196, v196, v144, v148
v_max3_u32 v196, v196, v152, v156
v_max_u32 v196, v196, v160
v_cmp_eq_u32 s[58:59], -1, v196
s_nop 1
s_cmp_eq_u64 s[58:59], 0
s_cbranch_scc0 L_fb_r
L_ok_r:
v_add_f32 v100, v100, v132
v_add_f32 v101, v101, v133
buffer_load_dwordx4 a[248:251], v251, s[32:35], s85 offen offset:1024 sc1
v_add_f32 v102, v102, v134
v_add_f32 v103, v103, v135
v_add_f32 v104, v104, v136
v_add_f32 v105, v105, v137
v_add_f32 v106, v106, v138
v_add_f32 v107, v107, v139
v_add_f32 v108, v108, v140
v_add_f32 v109, v109, v141
v_add_f32 v110, v110, v142
v_add_f32 v111, v111, v143
v_add_f32 v112, v112, v144
v_add_f32 v113, v113, v145
v_add_f32 v114, v114, v146
v_add_f32 v115, v115, v147
v_add_f32 v116, v116, v148
v_add_f32 v117, v117, v149
v_add_f32 v118, v118, v150
v_add_f32 v119, v119, v151
buffer_load_dwordx4 a[252:255], v252, s[32:35], s85 offen offset:1024 sc1
v_add_f32 v120, v120, v152
v_add_f32 v121, v121, v153
v_add_f32 v122, v122, v154
v_add_f32 v123, v123, v155
v_add_f32 v124, v124, v156
v_add_f32 v125, v125, v157
v_add_f32 v126, v126, v158
v_add_f32 v127, v127, v159
v_add_f32 v128, v128, v160
v_add_f32 v129, v129, v161
v_add_f32 v130, v130, v162
v_add_f32 v131, v131, v163
v_add_f32 v100, v100, v116
v_add_f32 v101, v101, v117
v_add_f32 v102, v102, v118
v_add_f32 v103, v103, v119
v_add_f32 v104, v104, v120
v_add_f32 v105, v105, v121
s_add_u32 s85, s79, 6144
buffer_load_dwordx4 a[160:163], v253, s[32:35], s85 offen offset:2048 sc1
v_add_f32 v106, v106, v122
v_add_f32 v107, v107, v123
v_add_f32 v108, v108, v124
v_add_f32 v109, v109, v125
v_add_f32 v110, v110, v126
v_add_f32 v111, v111, v127
v_add_f32 v112, v112, v128
v_add_f32 v113, v113, v129
v_add_f32 v114, v114, v130
v_add_f32 v115, v115, v131
v_add_f32 v100, v100, v108
v_add_f32 v101, v101, v109
v_add_f32 v102, v102, v110
v_add_f32 v103, v103, v111
v_add_f32 v104, v104, v112
v_add_f32 v105, v105, v113
v_add_f32 v106, v106, v114
v_add_f32 v107, v107, v115
buffer_load_dwordx4 a[164:167], v250, s[32:35], s85 offen offset:2048 sc1
v_add_f32 v100, v100, v104
v_add_f32 v101, v101, v105
v_add_f32 v102, v102, v106
v_add_f32 v103, v103, v107
v_cvt_pk_bf16_f32 v104, v100, v101
v_cvt_pk_bf16_f32 v105, v102, v103
ds_write_b64 v238, v[104:105]
s_waitcnt lgkmcnt(0)
buffer_load_dwordx4 a[168:171], v251, s[32:35], s85 offen offset:2048 sc1
s_barrier
ds_read_b128 v[108:111], v239 offset:0
ds_read_b128 v[112:115], v239 offset:32
ds_read_b128 v[116:119], v239 offset:64
buffer_load_dwordx4 a[172:175], v252, s[32:35], s85 offen offset:2048 sc1
ds_read_b128 v[120:123], v239 offset:96
s_waitcnt lgkmcnt(3)
v_mfma_f32_32x32x16_bf16 v[124:139], v[108:111], v[220:223], 0
s_add_u32 s85, s79, 9216
buffer_load_dwordx4 a[176:179], v253, s[32:35], s85 offen offset:0 sc1
s_waitcnt lgkmcnt(1)
v_mfma_f32_32x32x16_bf16 v[140:155], v[116:119], v[224:227], 0
buffer_load_dwordx4 a[180:183], v250, s[32:35], s85 offen offset:0 sc1
v_mfma_f32_32x32x16_bf16 v[124:139], v[112:115], v[224:227], v[124:139]
s_waitcnt lgkmcnt(0)
v_mfma_f32_32x32x16_bf16 v[140:155], v[120:123], v[228:231], v[140:155]
buffer_load_dwordx4 a[184:187], v251, s[32:35], s85 offen offset:0 sc1
s_nop 8
v_add_f32 v136, s70, v136
v_rcp_f32 v136, v136
v_add_f32 v152, s70, v152
buffer_load_dwordx4 a[188:191], v252, s[32:35], s85 offen offset:0 sc1
v_rcp_f32 v152, v152
v_mul_f32 v124, v124, v136
v_mul_f32 v125, v125, v136
v_mul_f32 v126, v126, v136
v_mul_f32 v127, v127, v136
v_mul_f32 v128, v128, v136
v_mul_f32 v129, v129, v136
v_mul_f32 v130, v130, v136
v_mul_f32 v131, v131, v136
v_mul_f32 v132, v132, v136
v_mul_f32 v133, v133, v136
v_mul_f32 v134, v134, v136
v_mul_f32 v135, v135, v136
v_cvt_pk_bf16_f32 v108, v124, v125
v_cvt_pk_bf16_f32 v109, v126, v127
v_cvt_pk_bf16_f32 v110, v128, v129
v_cvt_pk_bf16_f32 v111, v130, v131
s_add_u32 s85, s79, 9216
buffer_load_dwordx4 a[192:195], v253, s[32:35], s85 offen offset:1024 sc1
v_cvt_pk_bf16_f32 v116, v132, v133
v_cvt_pk_bf16_f32 v117, v134, v135
v_min_u32 v108, -2, v108
buffer_store_dwordx4 v[108:111], v240, s[32:35], s67 offen offset:0 sc1
v_mul_f32 v140, v140, v152
v_mul_f32 v141, v141, v152
v_mul_f32 v142, v142, v152
v_mul_f32 v143, v143, v152
v_mul_f32 v144, v144, v152
v_mul_f32 v145, v145, v152
v_mul_f32 v146, v146, v152
v_mul_f32 v147, v147, v152
v_mul_f32 v148, v148, v152
v_mul_f32 v149, v149, v152
v_mul_f32 v150, v150, v152
v_mul_f32 v151, v151, v152
v_cvt_pk_bf16_f32 v112, v140, v141
v_cvt_pk_bf16_f32 v113, v142, v143
v_cvt_pk_bf16_f32 v114, v144, v145
v_cvt_pk_bf16_f32 v115, v146, v147
v_cvt_pk_bf16_f32 v118, v148, v149
v_cvt_pk_bf16_f32 v119, v150, v151
v_min_u32 v112, -2, v112
buffer_store_dwordx4 v[112:115], v240, s[32:35], s67 offen offset:512 sc1
v_min_u32 v116, -2, v116
s_mov_b32 exec_hi, 0
buffer_store_dwordx4 v[116:119], v240, s[32:35], s67 offen offset:1024 sc1
s_mov_b32 exec_hi, -1
s_waitcnt vmcnt(19)
v_mfma_f32_16x16x32_bf16 v[16:19], a[120:123], a[224:227], v[16:19]
ds_read_b128 a[0:3], v6 offset:0
v_mfma_f32_16x16x32_bf16 v[32:35], a[124:127], a[224:227], v[32:35]
ds_read_b128 a[4:7], v6 offset:1024
v_mfma_f32_16x16x32_bf16 v[48:51], a[128:131], a[224:227], v[48:51]
ds_read_b128 a[8:11], v6 offset:2048
v_mfma_f32_16x16x32_bf16 v[64:67], a[132:135], a[224:227], v[64:67]
ds_read_b128 a[12:15], v6 offset:3072
v_mfma_f32_16x16x32_bf16 v[80:83], a[136:139], a[224:227], v[80:83]
ds_read_b128 a[16:19], v6 offset:4096
s_waitcnt vmcnt(18)
v_mfma_f32_16x16x32_bf16 v[20:23], a[120:123], a[228:231], v[20:23]
ds_read_b128 a[20:23], v6 offset:5120
v_mfma_f32_16x16x32_bf16 v[36:39], a[124:127], a[228:231], v[36:39]
ds_read_b128 a[24:27], v6 offset:6144
v_mfma_f32_16x16x32_bf16 v[52:55], a[128:131], a[228:231], v[52:55]
ds_read_b128 a[28:31], v6 offset:7168
v_mfma_f32_16x16x32_bf16 v[68:71], a[132:135], a[228:231], v[68:71]
ds_read_b128 a[32:35], v6 offset:8192
v_mfma_f32_16x16x32_bf16 v[84:87], a[136:139], a[228:231], v[84:87]
ds_read_b128 a[36:39], v6 offset:9216
s_waitcnt vmcnt(17)
v_mfma_f32_16x16x32_bf16 v[24:27], a[120:123], a[232:235], v[24:27]
buffer_load_dwordx4 a[196:199], v250, s[32:35], s85 offen offset:1024 sc1
v_mfma_f32_16x16x32_bf16 v[40:43], a[124:127], a[232:235], v[40:43]
ds_read_b128 a[40:43], v6 offset:10240
v_mfma_f32_16x16x32_bf16 v[56:59], a[128:131], a[232:235], v[56:59]
ds_read_b128 a[44:47], v6 offset:11264
v_mfma_f32_16x16x32_bf16 v[72:75], a[132:135], a[232:235], v[72:75]
ds_read_b128 a[48:51], v6 offset:12288
v_mfma_f32_16x16x32_bf16 v[88:91], a[136:139], a[232:235], v[88:91]
buffer_load_dwordx4 a[200:203], v251, s[32:35], s85 offen offset:1024 sc1
s_waitcnt vmcnt(18)
v_mfma_f32_16x16x32_bf16 v[28:31], a[120:123], a[236:239], v[28:31]
ds_read_b128 a[52:55], v5 offset:4096
v_mfma_f32_16x16x32_bf16 v[44:47], a[124:127], a[236:239], v[44:47]
ds_read_b128 a[56:59], v5 offset:8192
v_mfma_f32_16x16x32_bf16 v[60:63], a[128:131], a[236:239], v[60:63]
buffer_load_dwordx4 a[204:207], v252, s[32:35], s85 offen offset:1024 sc1
v_mfma_f32_16x16x32_bf16 v[76:79], a[132:135], a[236:239], v[76:79]
v_mfma_f32_16x16x32_bf16 v[92:95], a[136:139], a[236:239], v[92:95]
s_waitcnt vmcnt(18)
v_mfma_f32_16x16x32_bf16 v[16:19], a[140:143], a[240:243], v[16:19]
s_add_u32 s85, s79, 9216
buffer_load_dwordx4 a[208:211], v253, s[32:35], s85 offen offset:2048 sc1
v_mfma_f32_16x16x32_bf16 v[32:35], a[144:147], a[240:243], v[32:35]
ds_read_b128 a[120:123], v4 offset:0
v_mfma_f32_16x16x32_bf16 v[48:51], a[148:151], a[240:243], v[48:51]
ds_read_b128 a[124:127], v4 offset:1024
v_mfma_f32_16x16x32_bf16 v[64:67], a[152:155], a[240:243], v[64:67]
buffer_load_dwordx4 a[212:215], v250, s[32:35], s85 offen offset:2048 sc1
v_mfma_f32_16x16x32_bf16 v[80:83], a[156:159], a[240:243], v[80:83]
ds_read_b128 a[128:131], v4 offset:2048
s_waitcnt vmcnt(19)
v_mfma_f32_16x16x32_bf16 v[20:23], a[140:143], a[244:247], v[20:23]
ds_read_b128 a[132:135], v4 offset:3072
v_mfma_f32_16x16x32_bf16 v[36:39], a[144:147], a[244:247], v[36:39]
ds_read_b128 a[136:139], v4 offset:4096
v_mfma_f32_16x16x32_bf16 v[52:55], a[148:151], a[244:247], v[52:55]
buffer_load_dwordx4 a[216:219], v251, s[32:35], s85 offen offset:2048 sc1
v_mfma_f32_16x16x32_bf16 v[68:71], a[152:155], a[244:247], v[68:71]
v_mfma_f32_16x16x32_bf16 v[84:87], a[156:159], a[244:247], v[84:87]
s_waitcnt vmcnt(19)
v_mfma_f32_16x16x32_bf16 v[24:27], a[140:143], a[248:251], v[24:27]
buffer_load_dwordx4 a[220:223], v252, s[32:35], s85 offen offset:2048 sc1
v_mfma_f32_16x16x32_bf16 v[40:43], a[144:147], a[248:251], v[40:43]
v_mfma_f32_16x16x32_bf16 v[56:59], a[148:151], a[248:251], v[56:59]
v_mfma_f32_16x16x32_bf16 v[72:75], a[152:155], a[248:251], v[72:75]
s_add_u32 s84, s82, 10240
buffer_load_dwordx4 a[60:63], v232, s[32:35], s84 offen offset:0 sc1
v_mfma_f32_16x16x32_bf16 v[88:91], a[156:159], a[248:251], v[88:91]
s_waitcnt vmcnt(20)
v_mfma_f32_16x16x32_bf16 v[28:31], a[140:143], a[252:255], v[28:31]
v_mfma_f32_16x16x32_bf16 v[44:47], a[144:147], a[252:255], v[44:47]
buffer_load_dwordx4 a[64:67], v232, s[32:35], s84 offen offset:1024 sc1
v_mfma_f32_16x16x32_bf16 v[60:63], a[148:151], a[252:255], v[60:63]
v_mfma_f32_16x16x32_bf16 v[76:79], a[152:155], a[252:255], v[76:79]
v_mfma_f32_16x16x32_bf16 v[92:95], a[156:159], a[252:255], v[92:95]
s_waitcnt vmcnt(20) lgkmcnt(4)
v_mfma_f32_16x16x32_bf16 v[16:19], a[120:123], a[160:163], v[16:19]
buffer_load_dwordx4 a[68:71], v232, s[32:35], s84 offen offset:2048 sc1
s_waitcnt lgkmcnt(3)
v_mfma_f32_16x16x32_bf16 v[32:35], a[124:127], a[160:163], v[32:35]
ds_read_b128 a[140:143], v4 offset:5120
s_waitcnt lgkmcnt(3)
v_mfma_f32_16x16x32_bf16 v[48:51], a[128:131], a[160:163], v[48:51]
ds_read_b128 a[144:147], v4 offset:6144
s_waitcnt lgkmcnt(3)
v_mfma_f32_16x16x32_bf16 v[64:67], a[132:135], a[160:163], v[64:67]
buffer_load_dwordx4 a[72:75], v232, s[32:35], s84 offen offset:3072 sc1
s_waitcnt lgkmcnt(2)
v_mfma_f32_16x16x32_bf16 v[80:83], a[136:139], a[160:163], v[80:83]
ds_read_b128 a[148:151], v4 offset:7168
s_waitcnt vmcnt(21)
v_mfma_f32_16x16x32_bf16 v[20:23], a[120:123], a[164:167], v[20:23]
ds_read_b128 a[152:155], v4 offset:8192
v_mfma_f32_16x16x32_bf16 v[36:39], a[124:127], a[164:167], v[36:39]
buffer_load_dwordx4 a[76:79], v249, s[32:35], s84 offen offset:0 sc1
v_mfma_f32_16x16x32_bf16 v[52:55], a[128:131], a[164:167], v[52:55]
ds_read_b128 a[156:159], v4 offset:9216
v_mfma_f32_16x16x32_bf16 v[68:71], a[132:135], a[164:167], v[68:71]
v_mfma_f32_16x16x32_bf16 v[84:87], a[136:139], a[164:167], v[84:87]
s_add_u32 s84, s82, 15360
buffer_load_dwordx4 a[80:83], v232, s[32:35], s84 offen offset:0 sc1
s_waitcnt vmcnt(22)
v_mfma_f32_16x16x32_bf16 v[24:27], a[120:123], a[168:171], v[24:27]
v_mfma_f32_16x16x32_bf16 v[40:43], a[124:127], a[168:171], v[40:43]
v_mfma_f32_16x16x32_bf16 v[56:59], a[128:131], a[168:171], v[56:59]
buffer_load_dwordx4 a[84:87], v232, s[32:35], s84 offen offset:1024 sc1
v_mfma_f32_16x16x32_bf16 v[72:75], a[132:135], a[168:171], v[72:75]
v_mfma_f32_16x16x32_bf16 v[88:91], a[136:139], a[168:171], v[88:91]
s_waitcnt vmcnt(22)
v_mfma_f32_16x16x32_bf16 v[28:31], a[120:123], a[172:175], v[28:31]
v_mfma_f32_16x16x32_bf16 v[44:47], a[124:127], a[172:175], v[44:47]
buffer_load_dwordx4 a[88:91], v232, s[32:35], s84 offen offset:2048 sc1
v_mfma_f32_16x16x32_bf16 v[60:63], a[128:131], a[172:175], v[60:63]
v_mfma_f32_16x16x32_bf16 v[76:79], a[132:135], a[172:175], v[76:79]
v_mfma_f32_16x16x32_bf16 v[92:95], a[136:139], a[172:175], v[92:95]
buffer_load_dwordx4 a[92:95], v232, s[32:35], s84 offen offset:3072 sc1
s_waitcnt vmcnt(23) lgkmcnt(4)
v_mfma_f32_16x16x32_bf16 v[16:19], a[140:143], a[176:179], v[16:19]
s_waitcnt lgkmcnt(3)
v_mfma_f32_16x16x32_bf16 v[32:35], a[144:147], a[176:179], v[32:35]
ds_read_b128 a[120:123], v4 offset:10240
s_waitcnt lgkmcnt(3)
v_mfma_f32_16x16x32_bf16 v[48:51], a[148:151], a[176:179], v[48:51]
buffer_load_dwordx4 a[96:99], v249, s[32:35], s84 offen offset:0 sc1
s_waitcnt lgkmcnt(2)
v_mfma_f32_16x16x32_bf16 v[64:67], a[152:155], a[176:179], v[64:67]
ds_read_b128 a[124:127], v5 offset:0
s_waitcnt lgkmcnt(2)
v_mfma_f32_16x16x32_bf16 v[80:83], a[156:159], a[176:179], v[80:83]
ds_read_b128 a[128:131], v5 offset:28672
s_waitcnt vmcnt(23)
v_mfma_f32_16x16x32_bf16 v[20:23], a[140:143], a[180:183], v[20:23]
ds_read_b128 a[132:135], v5 offset:57344
v_mfma_f32_16x16x32_bf16 v[36:39], a[144:147], a[180:183], v[36:39]
s_add_u32 s84, s82, 20480
buffer_load_dwordx4 a[100:103], v232, s[32:35], s84 offen offset:0 sc1
v_mfma_f32_16x16x32_bf16 v[52:55], a[148:151], a[180:183], v[52:55]
ds_read_b128 a[136:139], v5 offset:20480
v_mfma_f32_16x16x32_bf16 v[68:71], a[152:155], a[180:183], v[68:71]
v_mfma_f32_16x16x32_bf16 v[84:87], a[156:159], a[180:183], v[84:87]
buffer_load_dwordx4 a[104:107], v232, s[32:35], s84 offen offset:1024 sc1
s_waitcnt vmcnt(24)
v_mfma_f32_16x16x32_bf16 v[24:27], a[140:143], a[184:187], v[24:27]
v_mfma_f32_16x16x32_bf16 v[40:43], a[144:147], a[184:187], v[40:43]
v_mfma_f32_16x16x32_bf16 v[56:59], a[148:151], a[184:187], v[56:59]
buffer_load_dwordx4 a[108:111], v232, s[32:35], s84 offen offset:2048 sc1
v_mfma_f32_16x16x32_bf16 v[72:75], a[152:155], a[184:187], v[72:75]
v_mfma_f32_16x16x32_bf16 v[88:91], a[156:159], a[184:187], v[88:91]
s_waitcnt vmcnt(24)
v_mfma_f32_16x16x32_bf16 v[28:31], a[140:143], a[188:191], v[28:31]
buffer_load_dwordx4 a[112:115], v232, s[32:35], s84 offen offset:3072 sc1
v_mfma_f32_16x16x32_bf16 v[44:47], a[144:147], a[188:191], v[44:47]
v_mfma_f32_16x16x32_bf16 v[60:63], a[148:151], a[188:191], v[60:63]
v_mfma_f32_16x16x32_bf16 v[76:79], a[152:155], a[188:191], v[76:79]
buffer_load_dwordx4 a[116:119], v249, s[32:35], s84 offen offset:0 sc1
v_mfma_f32_16x16x32_bf16 v[92:95], a[156:159], a[188:191], v[92:95]
s_waitcnt vmcnt(25) lgkmcnt(4)
v_mfma_f32_16x16x32_bf16 v[16:19], a[120:123], a[192:195], v[16:19]
s_waitcnt lgkmcnt(3)
v_mfma_f32_16x16x32_bf16 v[32:35], a[124:127], a[192:195], v[32:35]
s_waitcnt lgkmcnt(2)
v_mfma_f32_16x16x32_bf16 v[48:51], a[128:131], a[192:195], v[48:51]
buffer_load_dwordx4 v[100:103], v253, s[32:35], s81 offen offset:0 sc1
s_waitcnt lgkmcnt(1)
v_mfma_f32_16x16x32_bf16 v[64:67], a[132:135], a[192:195], v[64:67]
s_waitcnt lgkmcnt(0)
v_mfma_f32_16x16x32_bf16 v[80:83], a[136:139], a[192:195], v[80:83]
s_waitcnt vmcnt(22)
v_mfma_f32_16x16x32_bf16 v[20:23], a[120:123], a[196:199], v[20:23]
buffer_load_dwordx4 v[104:107], v253, s[32:35], s81 offen offset:1024 sc1
v_mfma_f32_16x16x32_bf16 v[36:39], a[124:127], a[196:199], v[36:39]
v_mfma_f32_16x16x32_bf16 v[52:55], a[128:131], a[196:199], v[52:55]
v_mfma_f32_16x16x32_bf16 v[68:71], a[132:135], a[196:199], v[68:71]
buffer_load_dwordx4 v[108:111], v253, s[32:35], s81 offen offset:2048 sc1
v_mfma_f32_16x16x32_bf16 v[84:87], a[136:139], a[196:199], v[84:87]
s_waitcnt vmcnt(23)
v_mfma_f32_16x16x32_bf16 v[24:27], a[120:123], a[200:203], v[24:27]
v_mfma_f32_16x16x32_bf16 v[40:43], a[124:127], a[200:203], v[40:43]
v_mfma_f32_16x16x32_bf16 v[56:59], a[128:131], a[200:203], v[56:59]
buffer_load_dwordx4 v[112:115], v253, s[32:35], s81 offen offset:3072 sc1
v_mfma_f32_16x16x32_bf16 v[72:75], a[132:135], a[200:203], v[72:75]
v_mfma_f32_16x16x32_bf16 v[88:91], a[136:139], a[200:203], v[88:91]
s_waitcnt vmcnt(23)
v_mfma_f32_16x16x32_bf16 v[28:31], a[120:123], a[204:207], v[28:31]
s_add_u32 s85, s81, 4096
buffer_load_dwordx4 v[116:119], v253, s[32:35], s85 offen offset:0 sc1
v_mfma_f32_16x16x32_bf16 v[44:47], a[124:127], a[204:207], v[44:47]
v_mfma_f32_16x16x32_bf16 v[60:63], a[128:131], a[204:207], v[60:63]
v_mfma_f32_16x16x32_bf16 v[76:79], a[132:135], a[204:207], v[76:79]
buffer_load_dwordx4 v[120:123], v250, s[32:35], s81 offen offset:0 sc1
v_mfma_f32_16x16x32_bf16 v[92:95], a[136:139], a[204:207], v[92:95]
s_waitcnt vmcnt(24)
v_mfma_f32_16x16x32_bf16 v[16:19], a[0:3], a[208:211], v[16:19]
v_mfma_f32_16x16x32_bf16 v[32:35], a[4:7], a[208:211], v[32:35]
buffer_load_dwordx4 v[124:127], v250, s[32:35], s81 offen offset:1024 sc1
v_mfma_f32_16x16x32_bf16 v[48:51], a[8:11], a[208:211], v[48:51]
v_mfma_f32_16x16x32_bf16 v[64:67], a[12:15], a[208:211], v[64:67]
v_mfma_f32_16x16x32_bf16 v[80:83], a[16:19], a[208:211], v[80:83]
buffer_load_dwordx4 v[128:131], v250, s[32:35], s81 offen offset:2048 sc1
s_waitcnt vmcnt(25)
v_mfma_f32_16x16x32_bf16 v[20:23], a[0:3], a[212:215], v[20:23]
v_mfma_f32_16x16x32_bf16 v[36:39], a[4:7], a[212:215], v[36:39]
v_mfma_f32_16x16x32_bf16 v[52:55], a[8:11], a[212:215], v[52:55]
v_mfma_f32_16x16x32_bf16 v[68:71], a[12:15], a[212:215], v[68:71]
buffer_load_dwordx4 v[132:135], v250, s[32:35], s81 offen offset:3072 sc1
v_mfma_f32_16x16x32_bf16 v[84:87], a[16:19], a[212:215], v[84:87]
s_waitcnt vmcnt(25)
v_mfma_f32_16x16x32_bf16 v[24:27], a[0:3], a[216:219], v[24:27]
v_mfma_f32_16x16x32_bf16 v[40:43], a[4:7], a[216:219], v[40:43]
s_add_u32 s85, s81, 4096
buffer_load_dwordx4 v[136:139], v250, s[32:35], s85 offen offset:0 sc1
v_mfma_f32_16x16x32_bf16 v[56:59], a[8:11], a[216:219], v[56:59]
v_mfma_f32_16x16x32_bf16 v[72:75], a[12:15], a[216:219], v[72:75]
v_mfma_f32_16x16x32_bf16 v[88:91], a[16:19], a[216:219], v[88:91]
buffer_load_dwordx4 v[140:143], v251, s[32:35], s81 offen offset:0 sc1
s_waitcnt vmcnt(26)
v_mfma_f32_16x16x32_bf16 v[28:31], a[0:3], a[220:223], v[28:31]
v_mfma_f32_16x16x32_bf16 v[44:47], a[4:7], a[220:223], v[44:47]
v_mfma_f32_16x16x32_bf16 v[60:63], a[8:11], a[220:223], v[60:63]
buffer_load_dwordx4 v[144:147], v251, s[32:35], s81 offen offset:1024 sc1
v_mfma_f32_16x16x32_bf16 v[76:79], a[12:15], a[220:223], v[76:79]
v_mfma_f32_16x16x32_bf16 v[92:95], a[16:19], a[220:223], v[92:95]
s_waitcnt vmcnt(7)
v_max3_u32 v15, v100, v104, v108
v_max3_u32 v15, v15, v112, v116
v_cmp_eq_u32 s[58:59], -1, v15
s_nop 1
s_cmp_eq_u64 s[58:59], 0
s_cbranch_scc0 L_fb_o0
L_ok_o0:
v_mfma_f32_16x16x32_bf16 v[16:19], a[20:23], v[100:103], v[16:19]
buffer_load_dwordx4 v[148:151], v251, s[32:35], s81 offen offset:2048 sc1
v_mfma_f32_16x16x32_bf16 v[32:35], a[24:27], v[100:103], v[32:35]
v_mfma_f32_16x16x32_bf16 v[48:51], a[28:31], v[100:103], v[48:51]
buffer_load_dwordx4 v[152:155], v251, s[32:35], s81 offen offset:3072 sc1
v_mfma_f32_16x16x32_bf16 v[64:67], a[32:35], v[100:103], v[64:67]
v_mfma_f32_16x16x32_bf16 v[80:83], a[36:39], v[100:103], v[80:83]
s_add_u32 s85, s81, 4096
buffer_load_dwordx4 v[156:159], v251, s[32:35], s85 offen offset:0 sc1
v_mfma_f32_16x16x32_bf16 v[16:19], a[40:43], v[104:107], v[16:19]
v_mfma_f32_16x16x32_bf16 v[32:35], a[44:47], v[104:107], v[32:35]
buffer_load_dwordx4 v[160:163], v252, s[32:35], s81 offen offset:0 sc1
v_mfma_f32_16x16x32_bf16 v[48:51], a[48:51], v[104:107], v[48:51]
v_mfma_f32_16x16x32_bf16 v[64:67], a[52:55], v[104:107], v[64:67]
buffer_load_dwordx4 v[164:167], v252, s[32:35], s81 offen offset:1024 sc1
v_mfma_f32_16x16x32_bf16 v[80:83], a[56:59], v[104:107], v[80:83]
v_mfma_f32_16x16x32_bf16 v[16:19], a[60:63], v[108:111], v[16:19]
buffer_load_dwordx4 v[168:171], v252, s[32:35], s81 offen offset:2048 sc1
v_mfma_f32_16x16x32_bf16 v[32:35], a[64:67], v[108:111], v[32:35]
v_mfma_f32_16x16x32_bf16 v[48:51], a[68:71], v[108:111], v[48:51]
buffer_load_dwordx4 v[172:175], v252, s[32:35], s81 offen offset:3072 sc1
v_mfma_f32_16x16x32_bf16 v[64:67], a[72:75], v[108:111], v[64:67]
v_mfma_f32_16x16x32_bf16 v[80:83], a[76:79], v[108:111], v[80:83]
s_add_u32 s85, s81, 4096
buffer_load_dwordx4 v[176:179], v252, s[32:35], s85 offen offset:0 sc1
v_mfma_f32_16x16x32_bf16 v[16:19], a[80:83], v[112:115], v[16:19]
v_mfma_f32_16x16x32_bf16 v[32:35], a[84:87], v[112:115], v[32:35]
v_mfma_f32_16x16x32_bf16 v[48:51], a[88:91], v[112:115], v[48:51]
v_mfma_f32_16x16x32_bf16 v[64:67], a[92:95], v[112:115], v[64:67]
v_mfma_f32_16x16x32_bf16 v[80:83], a[96:99], v[112:115], v[80:83]
v_mfma_f32_16x16x32_bf16 v[16:19], a[100:103], v[116:119], v[16:19]
v_mfma_f32_16x16x32_bf16 v[32:35], a[104:107], v[116:119], v[32:35]
v_mfma_f32_16x16x32_bf16 v[48:51], a[108:111], v[116:119], v[48:51]
v_mfma_f32_16x16x32_bf16 v[64:67], a[112:115], v[116:119], v[64:67]
v_mfma_f32_16x16x32_bf16 v[80:83], a[116:119], v[116:119], v[80:83]
s_waitcnt vmcnt(10)
v_max3_u32 v15, v120, v124, v128
v_max3_u32 v15, v15, v132, v136
v_cmp_eq_u32 s[58:59], -1, v15
s_nop 1
s_cmp_eq_u64 s[58:59], 0
s_cbranch_scc0 L_fb_o1
L_ok_o1:
v_mfma_f32_16x16x32_bf16 v[20:23], a[20:23], v[120:123], v[20:23]
v_mfma_f32_16x16x32_bf16 v[36:39], a[24:27], v[120:123], v[36:39]
ds_write_b128 v1, v[16:19] offset:0
v_mfma_f32_16x16x32_bf16 v[52:55], a[28:31], v[120:123], v[52:55]
v_mfma_f32_16x16x32_bf16 v[68:71], a[32:35], v[120:123], v[68:71]
ds_write_b128 v1, v[32:35] offset:1024
v_mfma_f32_16x16x32_bf16 v[84:87], a[36:39], v[120:123], v[84:87]
v_mfma_f32_16x16x32_bf16 v[20:23], a[40:43], v[124:127], v[20:23]
ds_write_b128 v1, v[48:51] offset:2048
v_mfma_f32_16x16x32_bf16 v[36:39], a[44:47], v[124:127], v[36:39]
v_mfma_f32_16x16x32_bf16 v[52:55], a[48:51], v[124:127], v[52:55]
ds_write_b128 v1, v[64:67] offset:3072
v_mfma_f32_16x16x32_bf16 v[68:71], a[52:55], v[124:127], v[68:71]
v_mfma_f32_16x16x32_bf16 v[84:87], a[56:59], v[124:127], v[84:87]
ds_write_b128 v1, v[80:83] offset:4096
v_mfma_f32_16x16x32_bf16 v[20:23], a[60:63], v[128:131], v[20:23]
v_mfma_f32_16x16x32_bf16 v[36:39], a[64:67], v[128:131], v[36:39]
v_mfma_f32_16x16x32_bf16 v[52:55], a[68:71], v[128:131], v[52:55]
v_mfma_f32_16x16x32_bf16 v[68:71], a[72:75], v[128:131], v[68:71]
v_mfma_f32_16x16x32_bf16 v[84:87], a[76:79], v[128:131], v[84:87]
v_mfma_f32_16x16x32_bf16 v[20:23], a[80:83], v[132:135], v[20:23]
v_mfma_f32_16x16x32_bf16 v[36:39], a[84:87], v[132:135], v[36:39]
v_mfma_f32_16x16x32_bf16 v[52:55], a[88:91], v[132:135], v[52:55]
v_mfma_f32_16x16x32_bf16 v[68:71], a[92:95], v[132:135], v[68:71]
v_mfma_f32_16x16x32_bf16 v[84:87], a[96:99], v[132:135], v[84:87]
v_mfma_f32_16x16x32_bf16 v[20:23], a[100:103], v[136:139], v[20:23]
v_mfma_f32_16x16x32_bf16 v[36:39], a[104:107], v[136:139], v[36:39]
v_mfma_f32_16x16x32_bf16 v[52:55], a[108:111], v[136:139], v[52:55]
v_mfma_f32_16x16x32_bf16 v[68:71], a[112:115], v[136:139], v[68:71]
v_mfma_f32_16x16x32_bf16 v[84:87], a[116:119], v[136:139], v[84:87]
s_waitcnt vmcnt(5)
v_max3_u32 v15, v140, v144, v148
v_max3_u32 v15, v15, v152, v156
v_cmp_eq_u32 s[58:59], -1, v15
s_nop 1
s_cmp_eq_u64 s[58:59], 0
s_cbranch_scc0 L_fb_o2
L_ok_o2:
v_mfma_f32_16x16x32_bf16 v[24:27], a[20:23], v[140:143], v[24:27]
v_mfma_f32_16x16x32_bf16 v[40:43], a[24:27], v[140:143], v[40:43]
ds_write_b128 v7, v[20:23] offset:0
v_mfma_f32_16x16x32_bf16 v[56:59], a[28:31], v[140:143], v[56:59]
v_mfma_f32_16x16x32_bf16 v[72:75], a[32:35], v[140:143], v[72:75]
ds_write_b128 v7, v[36:39] offset:1024
v_mfma_f32_16x16x32_bf16 v[88:91], a[36:39], v[140:143], v[88:91]
v_mfma_f32_16x16x32_bf16 v[24:27], a[40:43], v[144:147], v[24:27]
ds_write_b128 v7, v[52:55] offset:2048
v_mfma_f32_16x16x32_bf16 v[40:43], a[44:47], v[144:147], v[40:43]
v_mfma_f32_16x16x32_bf16 v[56:59], a[48:51], v[144:147], v[56:59]
ds_write_b128 v7, v[68:71] offset:3072
v_mfma_f32_16x16x32_bf16 v[72:75], a[52:55], v[144:147], v[72:75]
v_mfma_f32_16x16x32_bf16 v[88:91], a[56:59], v[144:147], v[88:91]
ds_write_b128 v7, v[84:87] offset:4096
v_mfma_f32_16x16x32_bf16 v[24:27], a[60:63], v[148:151], v[24:27]
v_mfma_f32_16x16x32_bf16 v[40:43], a[64:67], v[148:151], v[40:43]
v_mfma_f32_16x16x32_bf16 v[56:59], a[68:71], v[148:151], v[56:59]
s_waitcnt lgkmcnt(0)
s_barrier
ds_read_b128 v[180:183], v2 offset:0
ds_read_b128 v[184:187], v2 offset:1024
v_mfma_f32_16x16x32_bf16 v[72:75], a[72:75], v[148:151], v[72:75]
ds_read_b128 v[188:191], v2 offset:2048
ds_read_b128 v[192:195], v2 offset:3072
ds_read_b128 v[196:199], v2 offset:4096
v_mfma_f32_16x16x32_bf16 v[88:91], a[76:79], v[148:151], v[88:91]
ds_read_b128 v[200:203], v2 offset:20480
ds_read_b128 v[204:207], v2 offset:21504
ds_read_b128 v[208:211], v2 offset:22528
v_mfma_f32_16x16x32_bf16 v[24:27], a[80:83], v[152:155], v[24:27]
ds_read_b128 v[212:215], v2 offset:23552
ds_read_b128 v[216:219], v2 offset:24576
v_mfma_f32_16x16x32_bf16 v[40:43], a[84:87], v[152:155], v[40:43]
v_mfma_f32_16x16x32_bf16 v[56:59], a[88:91], v[152:155], v[56:59]
v_mfma_f32_16x16x32_bf16 v[72:75], a[92:95], v[152:155], v[72:75]
v_mfma_f32_16x16x32_bf16 v[88:91], a[96:99], v[152:155], v[88:91]
v_mfma_f32_16x16x32_bf16 v[24:27], a[100:103], v[156:159], v[24:27]
v_mfma_f32_16x16x32_bf16 v[40:43], a[104:107], v[156:159], v[40:43]
v_mfma_f32_16x16x32_bf16 v[56:59], a[108:111], v[156:159], v[56:59]
v_mfma_f32_16x16x32_bf16 v[72:75], a[112:115], v[156:159], v[72:75]
v_mfma_f32_16x16x32_bf16 v[88:91], a[116:119], v[156:159], v[88:91]
s_waitcnt vmcnt(0)
v_max3_u32 v15, v160, v164, v168
v_max3_u32 v15, v15, v172, v176
v_cmp_eq_u32 s[58:59], -1, v15
s_nop 1
s_cmp_eq_u64 s[58:59], 0
s_cbranch_scc0 L_fb_o3
L_ok_o3:
v_mfma_f32_16x16x32_bf16 v[28:31], a[20:23], v[160:163], v[28:31]
v_mfma_f32_16x16x32_bf16 v[44:47], a[24:27], v[160:163], v[44:47]
ds_write_b128 v8, v[24:27] offset:0
v_mfma_f32_16x16x32_bf16 v[60:63], a[28:31], v[160:163], v[60:63]
v_mfma_f32_16x16x32_bf16 v[76:79], a[32:35], v[160:163], v[76:79]
ds_write_b128 v8, v[40:43] offset:1024
v_mfma_f32_16x16x32_bf16 v[92:95], a[36:39], v[160:163], v[92:95]
v_mfma_f32_16x16x32_bf16 v[28:31], a[40:43], v[164:167], v[28:31]
ds_write_b128 v8, v[56:59] offset:2048
v_mfma_f32_16x16x32_bf16 v[44:47], a[44:47], v[164:167], v[44:47]
v_mfma_f32_16x16x32_bf16 v[60:63], a[48:51], v[164:167], v[60:63]
ds_write_b128 v8, v[72:75] offset:3072
v_mfma_f32_16x16x32_bf16 v[76:79], a[52:55], v[164:167], v[76:79]
v_mfma_f32_16x16x32_bf16 v[92:95], a[56:59], v[164:167], v[92:95]
ds_write_b128 v8, v[88:91] offset:4096
s_waitcnt lgkmcnt(9)
v_add_f32 v180, v180, v200
v_add_f32 v181, v181, v201
v_mfma_f32_16x16x32_bf16 v[28:31], a[60:63], v[168:171], v[28:31]
v_add_f32 v182, v182, v202
v_add_f32 v183, v183, v203
s_waitcnt lgkmcnt(8)
v_add_f32 v184, v184, v204
v_mfma_f32_16x16x32_bf16 v[44:47], a[64:67], v[168:171], v[44:47]
v_add_f32 v185, v185, v205
v_add_f32 v186, v186, v206
v_add_f32 v187, v187, v207
v_mfma_f32_16x16x32_bf16 v[60:63], a[68:71], v[168:171], v[60:63]
s_waitcnt lgkmcnt(7)
v_add_f32 v188, v188, v208
v_add_f32 v189, v189, v209
v_add_f32 v190, v190, v210
v_mfma_f32_16x16x32_bf16 v[76:79], a[72:75], v[168:171], v[76:79]
v_add_f32 v191, v191, v211
s_waitcnt lgkmcnt(6)
v_add_f32 v192, v192, v212
v_add_f32 v193, v193, v213
v_mfma_f32_16x16x32_bf16 v[92:95], a[76:79], v[168:171], v[92:95]
v_add_f32 v194, v194, v214
v_add_f32 v195, v195, v215
s_waitcnt lgkmcnt(5)
v_add_f32 v196, v196, v216
v_mfma_f32_16x16x32_bf16 v[28:31], a[80:83], v[172:175], v[28:31]
v_add_f32 v197, v197, v217
v_add_f32 v198, v198, v218
v_add_f32 v199, v199, v219
v_mfma_f32_16x16x32_bf16 v[44:47], a[84:87], v[172:175], v[44:47]
s_waitcnt lgkmcnt(0)
s_barrier
ds_read_b128 v[100:103], v9 offset:0
ds_read_b128 v[104:107], v9 offset:1024
v_mfma_f32_16x16x32_bf16 v[60:63], a[88:91], v[172:175], v[60:63]
ds_read_b128 v[108:111], v9 offset:2048
ds_read_b128 v[112:115], v9 offset:3072
ds_read_b128 v[116:119], v9 offset:4096
v_mfma_f32_16x16x32_bf16 v[76:79], a[92:95], v[172:175], v[76:79]
v_mfma_f32_16x16x32_bf16 v[92:95], a[96:99], v[172:175], v[92:95]
v_mfma_f32_16x16x32_bf16 v[28:31], a[100:103], v[176:179], v[28:31]
s_waitcnt lgkmcnt(4)
v_add_f32 v180, v180, v100
v_add_f32 v181, v181, v101
v_add_f32 v182, v182, v102
v_mfma_f32_16x16x32_bf16 v[44:47], a[104:107], v[176:179], v[44:47]
v_add_f32 v183, v183, v103
s_waitcnt lgkmcnt(3)
v_add_f32 v184, v184, v104
v_add_f32 v185, v185, v105
v_mfma_f32_16x16x32_bf16 v[60:63], a[108:111], v[176:179], v[60:63]
v_add_f32 v186, v186, v106
v_add_f32 v187, v187, v107
s_waitcnt lgkmcnt(2)
v_add_f32 v188, v188, v108
v_mfma_f32_16x16x32_bf16 v[76:79], a[112:115], v[176:179], v[76:79]
v_add_f32 v189, v189, v109
v_add_f32 v190, v190, v110
v_add_f32 v191, v191, v111
v_mfma_f32_16x16x32_bf16 v[92:95], a[116:119], v[176:179], v[92:95]
s_waitcnt lgkmcnt(1)
v_add_f32 v192, v192, v112
v_add_f32 v193, v193, v113
v_add_f32 v194, v194, v114
v_add_f32 v195, v195, v115
s_waitcnt lgkmcnt(0)
v_add_f32 v196, v196, v116
v_add_f32 v197, v197, v117
v_add_f32 v198, v198, v118
v_add_f32 v199, v199, v119
v_add_f32 v180, v180, v28
v_add_f32 v181, v181, v29
v_add_f32 v182, v182, v30
v_add_f32 v183, v183, v31
v_cvt_pk_bf16_f32 v200, v180, v181
v_cvt_pk_bf16_f32 v201, v182, v183
v_add_f32 v184, v184, v44
v_add_f32 v185, v185, v45
v_add_f32 v186, v186, v46
v_add_f32 v187, v187, v47
v_cvt_pk_bf16_f32 v202, v184, v185
v_cvt_pk_bf16_f32 v203, v186, v187
s_nop 0
v_permlane16_swap_b32 v200, v202
v_permlane16_swap_b32 v201, v203
buffer_store_dwordx4 v[200:203], v14, s[28:31], s83 offen offset:0
v_add_f32 v188, v188, v60
v_add_f32 v189, v189, v61
v_add_f32 v190, v190, v62
v_add_f32 v191, v191, v63
v_cvt_pk_bf16_f32 v204, v188, v189
v_cvt_pk_bf16_f32 v205, v190, v191
v_add_f32 v192, v192, v76
v_add_f32 v193, v193, v77
v_add_f32 v194, v194, v78
v_add_f32 v195, v195, v79
v_cvt_pk_bf16_f32 v206, v192, v193
v_cvt_pk_bf16_f32 v207, v194, v195
s_nop 0
v_permlane16_swap_b32 v204, v206
v_permlane16_swap_b32 v205, v207
buffer_store_dwordx4 v[204:207], v14, s[28:31], s83 offen offset:64
v_add_f32 v196, v196, v92
v_add_f32 v197, v197, v93
v_add_f32 v198, v198, v94
v_add_f32 v199, v199, v95
v_cvt_pk_bf16_f32 v208, v196, v197
v_cvt_pk_bf16_f32 v209, v198, v199
buffer_store_dwordx2 v[208:209], v3, s[28:31], s83 offen offset:128
s_endpgm
.p2align 6
L_fb_dbg:
s_mov_b32 s3, 0
L_fbl_dbg:
v_mov_b32 v218, 0
buffer_load_dword v219, v218, s[36:39], 0 offen sc1
s_waitcnt vmcnt(0)
v_readfirstlane_b32 s58, v219
s_waitcnt vmcnt(0)
s_cmp_lg_u32 s58, 0
s_cbranch_scc1 L_ok_dbg
s_add_u32 s3, s3, 1
s_cmp_lt_u32 s3, 200000
s_cbranch_scc1 L_fbl_dbg
s_branch L_ok_dbg
L_fb_h1:
s_mov_b32 s3, 0
L_fbl_h1:
buffer_load_dword v217, v216, s[32:35], 0 offen sc1
s_waitcnt vmcnt(0)
v_cmp_ne_u32 s[58:59], 0, v217
s_nop 1
s_cmp_eq_u64 s[58:59], -1
s_cbranch_scc1 L_ok_h1
s_add_u32 s3, s3, 1
s_cmp_lt_u32 s3, 200000
s_cbranch_scc1 L_fbl_h1
s_branch L_ok_h1
L_fb_c:
s_mov_b32 s3, 0
L_fbl_c:
buffer_load_dword v236, v235, s[32:35], 0 offen sc1
s_waitcnt vmcnt(0)
v_cmp_ne_u32 s[58:59], 0, v236
s_nop 1
s_cmp_eq_u64 s[58:59], -1
s_cbranch_scc1 L_ok_c
s_add_u32 s3, s3, 1
s_cmp_lt_u32 s3, 200000
s_cbranch_scc1 L_fbl_c
s_branch L_ok_c
L_fb_h2:
s_lshr_b32 s3, s43, 1
s_lshl_b32 s3, s3, 7
v_and_b32 v235, 15, v0
v_lshl_add_u32 v235, v235, 2, s3
s_mov_b32 s3, 0
L_fbl_h2:
buffer_load_dword v236, v235, s[32:35], 0 offen sc1
s_waitcnt vmcnt(0)
v_cmp_eq_u32 s[58:59], 3, v236
s_nop 1
s_cmp_eq_u64 s[58:59], -1
s_cbranch_scc1 L_ok_h2
s_add_u32 s3, s3, 1
s_cmp_lt_u32 s3, 200000
s_cbranch_scc1 L_fbl_h2
s_branch L_ok_h2
L_fb_r:
s_mov_b32 s3, 0
L_fbl_r:
s_mul_i32 s78, s42, 57344
s_add_u32 s78, s78, 14667776
buffer_load_dwordx4 v[100:103], v237, s[32:35], s78 offen offset:0 sc1
buffer_load_dwordx4 v[104:107], v237, s[32:35], s78 offen offset:3584 sc1
s_add_u32 s78, s78, 7168
buffer_load_dwordx4 v[108:111], v237, s[32:35], s78 offen offset:0 sc1
buffer_load_dwordx4 v[112:115], v237, s[32:35], s78 offen offset:3584 sc1
s_add_u32 s78, s78, 7168
buffer_load_dwordx4 v[116:119], v237, s[32:35], s78 offen offset:0 sc1
buffer_load_dwordx4 v[120:123], v237, s[32:35], s78 offen offset:3584 sc1
s_add_u32 s78, s78, 7168
buffer_load_dwordx4 v[124:127], v237, s[32:35], s78 offen offset:0 sc1
buffer_load_dwordx4 v[128:131], v237, s[32:35], s78 offen offset:3584 sc1
s_add_u32 s78, s78, 7168
buffer_load_dwordx4 v[132:135], v237, s[32:35], s78 offen offset:0 sc1
buffer_load_dwordx4 v[136:139], v237, s[32:35], s78 offen offset:3584 sc1
s_add_u32 s78, s78, 7168
buffer_load_dwordx4 v[140:143], v237, s[32:35], s78 offen offset:0 sc1
buffer_load_dwordx4 v[144:147], v237, s[32:35], s78 offen offset:3584 sc1
s_add_u32 s78, s78, 7168
buffer_load_dwordx4 v[148:151], v237, s[32:35], s78 offen offset:0 sc1
buffer_load_dwordx4 v[152:155], v237, s[32:35], s78 offen offset:3584 sc1
s_add_u32 s78, s78, 7168
buffer_load_dwordx4 v[156:159], v237, s[32:35], s78 offen offset:0 sc1
buffer_load_dwordx4 v[160:163], v237, s[32:35], s78 offen offset:3584 sc1
s_waitcnt vmcnt(0)
v_max3_u32 v196, v100, v104, v108
v_max3_u32 v196, v196, v112, v116
v_max3_u32 v196, v196, v120, v124
v_max3_u32 v196, v196, v128, v132
v_max3_u32 v196, v196, v136, v140
v_max3_u32 v196, v196, v144, v148
v_max3_u32 v196, v196, v152, v156
v_max_u32 v196, v196, v160
v_cmp_eq_u32 s[58:59], -1, v196
s_nop 1
s_cmp_eq_u64 s[58:59], 0
s_cbranch_scc1 L_ok_r
s_add_u32 s3, s3, 1
s_cmp_lt_u32 s3, 200000
s_cbranch_scc1 L_fbl_r
s_branch L_ok_r
L_fb_o0:
s_mov_b32 s3, 0
L_fbl_o0:
buffer_load_dwordx4 v[100:103], v253, s[32:35], s81 offen offset:0 sc1
buffer_load_dwordx4 v[104:107], v253, s[32:35], s81 offen offset:1024 sc1
buffer_load_dwordx4 v[108:111], v253, s[32:35], s81 offen offset:2048 sc1
buffer_load_dwordx4 v[112:115], v253, s[32:35], s81 offen offset:3072 sc1
s_add_u32 s85, s81, 4096
buffer_load_dwordx4 v[116:119], v253, s[32:35], s85 offen offset:0 sc1
buffer_load_dwordx4 v[120:123], v250, s[32:35], s81 offen offset:0 sc1
buffer_load_dwordx4 v[124:127], v250, s[32:35], s81 offen offset:1024 sc1
buffer_load_dwordx4 v[128:131], v250, s[32:35], s81 offen offset:2048 sc1
buffer_load_dwordx4 v[132:135], v250, s[32:35], s81 offen offset:3072 sc1
s_add_u32 s85, s81, 4096
buffer_load_dwordx4 v[136:139], v250, s[32:35], s85 offen offset:0 sc1
buffer_load_dwordx4 v[140:143], v251, s[32:35], s81 offen offset:0 sc1
buffer_load_dwordx4 v[144:147], v251, s[32:35], s81 offen offset:1024 sc1
buffer_load_dwordx4 v[148:151], v251, s[32:35], s81 offen offset:2048 sc1
buffer_load_dwordx4 v[152:155], v251, s[32:35], s81 offen offset:3072 sc1
s_add_u32 s85, s81, 4096
buffer_load_dwordx4 v[156:159], v251, s[32:35], s85 offen offset:0 sc1
buffer_load_dwordx4 v[160:163], v252, s[32:35], s81 offen offset:0 sc1
buffer_load_dwordx4 v[164:167], v252, s[32:35], s81 offen offset:1024 sc1
buffer_load_dwordx4 v[168:171], v252, s[32:35], s81 offen offset:2048 sc1
buffer_load_dwordx4 v[172:175], v252, s[32:35], s81 offen offset:3072 sc1
s_add_u32 s85, s81, 4096
buffer_load_dwordx4 v[176:179], v252, s[32:35], s85 offen offset:0 sc1
s_waitcnt vmcnt(0)
v_max3_u32 v15, v100, v104, v108
v_max3_u32 v15, v15, v112, v116
v_cmp_eq_u32 s[58:59], -1, v15
s_nop 1
s_cmp_eq_u64 s[58:59], 0
s_cbranch_scc1 L_ok_o0
s_add_u32 s3, s3, 1
s_cmp_lt_u32 s3, 200000
s_cbranch_scc1 L_fbl_o0
s_branch L_ok_o0
L_fb_o1:
s_mov_b32 s3, 0
L_fbl_o1:
buffer_load_dwordx4 v[120:123], v250, s[32:35], s81 offen offset:0 sc1
buffer_load_dwordx4 v[124:127], v250, s[32:35], s81 offen offset:1024 sc1
buffer_load_dwordx4 v[128:131], v250, s[32:35], s81 offen offset:2048 sc1
buffer_load_dwordx4 v[132:135], v250, s[32:35], s81 offen offset:3072 sc1
s_add_u32 s85, s81, 4096
buffer_load_dwordx4 v[136:139], v250, s[32:35], s85 offen offset:0 sc1
buffer_load_dwordx4 v[140:143], v251, s[32:35], s81 offen offset:0 sc1
buffer_load_dwordx4 v[144:147], v251, s[32:35], s81 offen offset:1024 sc1
buffer_load_dwordx4 v[148:151], v251, s[32:35], s81 offen offset:2048 sc1
buffer_load_dwordx4 v[152:155], v251, s[32:35], s81 offen offset:3072 sc1
s_add_u32 s85, s81, 4096
buffer_load_dwordx4 v[156:159], v251, s[32:35], s85 offen offset:0 sc1
buffer_load_dwordx4 v[160:163], v252, s[32:35], s81 offen offset:0 sc1
buffer_load_dwordx4 v[164:167], v252, s[32:35], s81 offen offset:1024 sc1
buffer_load_dwordx4 v[168:171], v252, s[32:35], s81 offen offset:2048 sc1
buffer_load_dwordx4 v[172:175], v252, s[32:35], s81 offen offset:3072 sc1
s_add_u32 s85, s81, 4096
buffer_load_dwordx4 v[176:179], v252, s[32:35], s85 offen offset:0 sc1
s_waitcnt vmcnt(0)
v_max3_u32 v15, v120, v124, v128
v_max3_u32 v15, v15, v132, v136
v_cmp_eq_u32 s[58:59], -1, v15
s_nop 1
s_cmp_eq_u64 s[58:59], 0
s_cbranch_scc1 L_ok_o1
s_add_u32 s3, s3, 1
s_cmp_lt_u32 s3, 200000
s_cbranch_scc1 L_fbl_o1
s_branch L_ok_o1
L_fb_o2:
s_mov_b32 s3, 0
L_fbl_o2:
buffer_load_dwordx4 v[140:143], v251, s[32:35], s81 offen offset:0 sc1
buffer_load_dwordx4 v[144:147], v251, s[32:35], s81 offen offset:1024 sc1
buffer_load_dwordx4 v[148:151], v251, s[32:35], s81 offen offset:2048 sc1
buffer_load_dwordx4 v[152:155], v251, s[32:35], s81 offen offset:3072 sc1
s_add_u32 s85, s81, 4096
buffer_load_dwordx4 v[156:159], v251, s[32:35], s85 offen offset:0 sc1
buffer_load_dwordx4 v[160:163], v252, s[32:35], s81 offen offset:0 sc1
buffer_load_dwordx4 v[164:167], v252, s[32:35], s81 offen offset:1024 sc1
buffer_load_dwordx4 v[168:171], v252, s[32:35], s81 offen offset:2048 sc1
buffer_load_dwordx4 v[172:175], v252, s[32:35], s81 offen offset:3072 sc1
s_add_u32 s85, s81, 4096
buffer_load_dwordx4 v[176:179], v252, s[32:35], s85 offen offset:0 sc1
s_waitcnt vmcnt(0)
v_max3_u32 v15, v140, v144, v148
v_max3_u32 v15, v15, v152, v156
v_cmp_eq_u32 s[58:59], -1, v15
s_nop 1
s_cmp_eq_u64 s[58:59], 0
s_cbranch_scc1 L_ok_o2
s_add_u32 s3, s3, 1
s_cmp_lt_u32 s3, 200000
s_cbranch_scc1 L_fbl_o2
s_branch L_ok_o2
L_fb_o3:
s_mov_b32 s3, 0
L_fbl_o3:
buffer_load_dwordx4 v[160:163], v252, s[32:35], s81 offen offset:0 sc1
buffer_load_dwordx4 v[164:167], v252, s[32:35], s81 offen offset:1024 sc1
buffer_load_dwordx4 v[168:171], v252, s[32:35], s81 offen offset:2048 sc1
buffer_load_dwordx4 v[172:175], v252, s[32:35], s81 offen offset:3072 sc1
s_add_u32 s85, s81, 4096
buffer_load_dwordx4 v[176:179], v252, s[32:35], s85 offen offset:0 sc1
s_waitcnt vmcnt(0)
v_max3_u32 v15, v160, v164, v168
v_max3_u32 v15, v15, v172, v176
v_cmp_eq_u32 s[58:59], -1, v15
s_nop 1
s_cmp_eq_u64 s[58:59], 0
s_cbranch_scc1 L_ok_o3
s_add_u32 s3, s3, 1
s_cmp_lt_u32 s3, 200000
s_cbranch_scc1 L_fbl_o3
s_branch L_ok_o3
L_end:
s_endpgm
.section .rodata,"a"
.p2align 6
.amdhsa_kernel parallel_sum__linear_attn_block__dense_activation_mish__prompt_kernel
  .amdhsa_next_free_vgpr 512
  .amdhsa_next_free_sgpr 102
  .amdhsa_accum_offset 256
  .amdhsa_group_segment_fixed_size 0
  .amdhsa_kernarg_size 80
  .amdhsa_user_sgpr_count 2
  .amdhsa_user_sgpr_kernarg_segment_ptr 1
  .amdhsa_system_sgpr_workgroup_id_x 1
.end_amdhsa_kernel
```
